```python
import torch

def _softmax(x, axis=-1):
    return torch.softmax(x, dim=axis)
def _gelu(x):
    return torch.nn.functional.gelu(x, approximate="tanh")
def _silu(x):
    return torch.nn.functional.silu(x)
def _sigmoid(x):
    return torch.sigmoid(x)
def _layernorm(x, axis=-1, eps=1e-5):
    m = x.mean(dim=axis, keepdim=True)
    v = x.var(dim=axis, keepdim=True, unbiased=False)
    return (x - m) / torch.sqrt(v + eps)
def _scatter_add(tgt, idx, src, axis=0):
    return tgt.clone().index_add_(axis, idx, src)
def _segment_sum(src, seg, n):
    out = torch.zeros((n,) + src.shape[1:], dtype=src.dtype)
    return out.index_add_(0, seg, src)
def _pad(x, pw):
    flat = tuple(v for pair in reversed(pw) for v in pair)
    return torch.nn.functional.pad(x, flat)

kernel_name = 'gated_mix__sliding_block__moe_arch_mod__prompt'

def setup_inputs():

    _w = (lambda a: (lambda t: t.to(torch.bfloat16) if t.is_floating_point() else t)(torch.as_tensor(a)))
    def _A_setup():
        B, S, D = 1, 2048, 576
        return {
            "x": _w((lambda *s: torch.randn(*s, dtype=torch.bfloat16) * 0.05)(B, S, D)),
            "wqkv": _w((lambda *s: torch.randn(*s, dtype=torch.bfloat16) * 0.8)(D, 3 * D)),
            "wo": _w((lambda *s: torch.randn(*s, dtype=torch.bfloat16) * 0.05)(D, D)),
        }
    _A_in = _A_setup()

    def _B_setup():
        B, S, D, F, C = 1, 2048, 576, 4608, 1
        return {
            "x": _w((lambda *s: torch.randn(*s, dtype=torch.bfloat16) * 0.05)(B, S, D)),
            "w_r": _w((lambda *s: torch.randn(*s, dtype=torch.bfloat16) * 3.2)(D)),
            "w_gate": _w((lambda *s: torch.randn(*s, dtype=torch.bfloat16) * 0.2)(D, F)),
            "w_up": _w((lambda *s: torch.randn(*s, dtype=torch.bfloat16) * 0.2)(D, F)),
            "w_down": _w((lambda *s: torch.randn(*s, dtype=torch.bfloat16) * 0.2)(F, D)),
        }
    _B_in = _B_setup()

    return {
        "A_x": _A_in["x"],
        "A_wqkv": _A_in["wqkv"],
        "A_wo": _A_in["wo"],
        "B_x": _B_in["x"],
        "B_w_r": _B_in["w_r"],
        "B_w_gate": _B_in["w_gate"],
        "B_w_up": _B_in["w_up"],
        "B_w_down": _B_in["w_down"],
        "gate_w": _w((lambda *s: torch.randn(*s, dtype=torch.bfloat16) * 0.05)(576) * 16.0),
    }

def reference(A_x, A_wqkv, A_wo, B_x, B_w_r, B_w_gate, B_w_up, B_w_down, gate_w):
    def _A_ref(x, wqkv, wo):
        B, S, D = x.shape
        H = 32; Dh = D // H; W = 256
        qkv = (lambda x, *d: x.permute(*d))((x @ wqkv).reshape(B, S, 3, H, Dh), 2, 0, 3, 1, 4)
        q, k, v = qkv[0], qkv[1], qkv[2]
        scores = torch.einsum("bhqd,bhkd->bhqk", q, k) * (Dh ** -0.5)
        idx = torch.arange(S)
        mask = (idx[:, None] - idx[None, :] >= 0) & (idx[:, None] - idx[None, :] < W)
        scores = torch.where(mask[None, None], scores, -1e9)
        p = _softmax(scores, axis=-1)
        o = torch.einsum("bhqk,bhkd->bhqd", p, v)
        return (lambda x, *d: x.permute(*d))(o, 0, 2, 1, 3).reshape(B, S, D) @ wo

    def _B_ref(x, w_r, w_gate, w_up, w_down):
        B, S, D = x.shape
        C = 1
        r = x @ w_r
        idx = torch.argsort(-r, axis=-1)[:, :C]
        idx_e = (lambda x, n, axis: torch.repeat_interleave(x, n, dim=axis))(idx.reshape(B, C, 1), D, axis=2)
        x_sel = (lambda x, i, axis: torch.take_along_dim(x, i, dim=axis))(x, idx_e, axis=1)
        g = _silu(x_sel @ w_gate)
        u = x_sel @ w_up
        y = (g * u) @ w_down
        r_sel = _sigmoid((lambda x, i, axis: torch.take_along_dim(x, i, dim=axis))(r, idx, axis=1))
        y = y * r_sel.reshape(B, C, 1)
        b_off = (torch.arange(B) * S).reshape(B, 1)
        flat_idx = (idx + b_off).reshape(B * C)
        zero = (x * 0.0).reshape(B * S, D)
        upd = _scatter_add(zero, flat_idx, y.reshape(B * C, D), axis=0)
        return x + upd.reshape(B, S, D)

    x = A_x
    g = _sigmoid((x * gate_w).sum(-1, keepdims=True))
    a = _A_ref(x, A_wqkv, A_wo)
    b = _B_ref(x, B_w_r, B_w_gate, B_w_up, B_w_down)
    return g * a + (1 - g) * b
```

```asm
; @launch grid=(256,1,1) block=(512,1,1) lds=163840
.amdgcn_target "amdgcn-amd-amdhsa--gfx950"
.text
.globl gated_mix__sliding_block__moe_arch_mod__prompt_kernel
.p2align 8
.type gated_mix__sliding_block__moe_arch_mod__prompt_kernel,@function
gated_mix__sliding_block__moe_arch_mod__prompt_kernel:
  s_memrealtime s[90:91]
  s_load_dwordx2 s[8:9], s[0:1], 0
  s_load_dwordx2 s[12:13], s[0:1], 8
  s_load_dwordx16 s[16:31], s[0:1], 0
  s_load_dwordx8 s[32:39], s[0:1], 64
  s_cmp_ge_u32 s2, 256
  s_cbranch_scc1 L_end
  v_lshrrev_b32 v2, 6, v0
  v_and_b32 v1, 63, v0
  v_readfirstlane_b32 s3, v2
  s_and_b32 s4, s2, 7
  s_lshr_b32 s5, s2, 3
  s_lshr_b32 s57, s5, 2
  s_and_b32 s58, s5, 3
  s_sub_u32 s5, s5, s57
  s_add_u32 s57, s57, 24
  s_cmp_eq_u32 s58, 3
  s_cselect_b32 s5, s57, s5
  s_and_b32 s6, s4, 3
  s_lshl_b32 s6, s6, 2
  s_and_b32 s57, s5, 3
  s_add_u32 s6, s6, s57
  s_lshr_b32 s7, s4, 2
  s_mul_i32 s7, s7, 6
  s_lshr_b32 s58, s5, 2
  s_add_u32 s7, s7, s58
  s_cmp_ge_u32 s5, 24
  s_cbranch_scc1 L_sphase
  s_cmp_lt_u32 s3, 4
  s_cbranch_scc1 L_compute
  s_setprio 3
  s_sub_u32 s59, s3, 4
  v_lshrrev_b32 v2, 3, v1
  v_mul_u32_u24 v2, 1152, v2
  v_lshrrev_b32 v3, 4, v1
  s_and_b32 s65, s59, 1
  s_lshl_b32 s65, s65, 2
  v_add_u32 v3, s65, v3
  v_and_b32 v4, 7, v1
  v_xor_b32 v3, v3, v4
  v_lshl_add_u32 v2, v3, 4, v2
  s_mov_b32 s70, 0x48362170
  s_mov_b32 s71, 5
  s_cmp_eq_u32 s57, 1
  s_cselect_b32 s70, 0x85703421, s70
  s_cselect_b32 s71, 6, s71
  s_cmp_eq_u32 s57, 2
  s_cselect_b32 s70, 0x54738012, s70
  s_cselect_b32 s71, 6, s71
  s_cmp_eq_u32 s57, 3
  s_cselect_b32 s70, 0x84750123, s70
  s_cselect_b32 s71, 6, s71
  s_mov_b32 s72, s58
  s_add_u32 s60, s57, s58
  s_mul_i32 s62, s6, 147456
  s_mul_i32 s57, s59, 9216
  s_add_u32 s62, s62, s57
  s_mul_i32 s63, s7, 288
  s_lshl_b32 s61, s59, 10
  s_lshl_b32 s57, s59, 6
  v_add_u32 v5, s57, v1
  v_mul_u32_u24 v6, 3641, v5
  v_lshlrev_b32 v5, 4, v5
  s_movk_i32 s57, 3168
  v_lshrrev_b32 v7, 16, v6
  v_mad_u32_u24 v8, v7, s57, v5
  v_add_u32 v6, 932096, v6
  v_add_u32 v5, 4096, v5
  v_lshrrev_b32 v7, 16, v6
  v_mad_u32_u24 v9, v7, s57, v5
  v_add_u32 v6, 932096, v6
  v_add_u32 v5, 4096, v5
  v_lshrrev_b32 v7, 16, v6
  v_mad_u32_u24 v10, v7, s57, v5
  v_add_u32 v6, 932096, v6
  v_add_u32 v5, 4096, v5
  v_lshrrev_b32 v7, 16, v6
  v_mad_u32_u24 v11, v7, s57, v5
  v_add_u32 v6, 932096, v6
  v_add_u32 v5, 4096, v5
  v_lshrrev_b32 v7, 16, v6
  v_mad_u32_u24 v12, v7, s57, v5
  s_mov_b32 s64, 0
  s_mov_b32 s10, 2359296
  s_mov_b32 s11, 0x20000
  s_mov_b32 s14, 1990656
  s_mov_b32 s15, 0x20000
  s_waitcnt lgkmcnt(0)
L_ld_loop:
  s_lshl_b32 s57, s60, 7
  s_add_u32 s57, s57, s62
  s_mul_i32 s58, s60, 221184
  s_add_u32 s58, s58, s63
  s_mov_b32 m0, s61
  s_nop 0
  buffer_load_dwordx4 v2, s[8:11], s57 offen  lds
  s_add_u32 s57, s57, 36864
  s_add_u32 m0, m0, 4096
  s_nop 0
  buffer_load_dwordx4 v2, s[8:11], s57 offen  lds
  s_add_u32 s57, s57, 36864
  s_add_u32 m0, m0, 4096
  s_nop 0
  buffer_load_dwordx4 v2, s[8:11], s57 offen  lds
  s_add_u32 s57, s57, 36864
  s_add_u32 m0, m0, 4096
  s_nop 0
  buffer_load_dwordx4 v2, s[8:11], s57 offen  lds
  s_add_u32 m0, m0, 4096
  s_nop 0
  buffer_load_dwordx4 v8, s[12:15], s58 offen  lds
  s_add_u32 m0, m0, 4096
  s_nop 0
  buffer_load_dwordx4 v9, s[12:15], s58 offen  lds
  s_add_u32 m0, m0, 4096
  s_nop 0
  buffer_load_dwordx4 v10, s[12:15], s58 offen  lds
  s_add_u32 m0, m0, 4096
  s_nop 0
  buffer_load_dwordx4 v11, s[12:15], s58 offen  lds
  s_cmp_ge_u32 s59, 2
  s_cbranch_scc1 L_ld_skip5
  s_add_u32 m0, m0, 4096
  s_nop 0
  buffer_load_dwordx4 v12, s[12:15], s58 offen  lds
L_ld_skip5:
  s_lshr_b64 s[70:71], s[70:71], 4
  s_and_b32 s60, s70, 15
  s_add_u32 s60, s60, s72
  s_cmp_ge_u32 s60, 9
  s_cselect_b32 s57, 9, 0
  s_sub_u32 s60, s60, s57
  s_add_u32 s61, s61, 34816
  s_cmp_ge_u32 s61, 139264
  s_cselect_b32 s57, 139264, 0
  s_sub_u32 s61, s61, s57
  s_add_u32 s64, s64, 1
  s_cmp_lt_u32 s64, 2
  s_cbranch_scc1 L_ld_loop
  s_cmp_eq_u32 s64, 2
  s_cbranch_scc0 L_ld_noinit
  v_mov_b32 v5, 160512
  v_mov_b32 v6, 0
  v_mov_b32 v7, 0
  ds_write_b64 v5, v[6:7] offset:0
  ds_write_b64 v5, v[6:7] offset:8
  ds_write_b64 v5, v[6:7] offset:16
  ds_write_b64 v5, v[6:7] offset:24
  s_waitcnt lgkmcnt(0)
L_ld_noinit:
  s_waitcnt vmcnt(8)
  s_barrier
  s_cmp_lt_u32 s64, 9
  s_cbranch_scc1 L_ld_loop
  s_lshl_b32 s66, s5, 2
  s_add_u32 s66, s66, s59
  s_mul_i32 s66, s66, 6912
  v_min_u32 v13, 53, v1
  v_lshlrev_b32 v13, 7, v13
  s_mov_b32 s48, s20
  s_mov_b32 s49, s21
  s_mov_b32 s50, 663552
  s_mov_b32 s51, 0x20000
  buffer_load_dword v60, v13, s[48:51], s66 offen
  s_waitcnt vmcnt(1)
  s_barrier
  s_setprio 0
  s_mov_b32 s40, s38
  s_mov_b32 s41, s39
  s_mov_b32 s42, 14680064
  s_mov_b32 s43, 0x20000
  s_mov_b32 s44, s34
  s_mov_b32 s45, s35
  s_mov_b32 s46, 2359296
  s_mov_b32 s47, 0x20000
  v_mov_b32 v18, 0
  global_load_dword v17, v18, s[36:37] sc1
  s_mov_b32 s81, 0
  s_mov_b32 s86, 0
  v_lshrrev_b32 v2, 3, v1
  s_lshr_b32 s57, s6, 1
  v_add_u32 v3, s57, v2
  s_and_b32 s57, s7, 3
  s_lshl_b32 s57, s57, 3
  v_and_b32 v4, 7, v1
  v_add_u32 v4, s57, v4
  v_lshl_add_u32 v4, v3, 5, v4
  v_lshlrev_b32 v4, 7, v4
  s_lshr_b32 s57, s7, 2
  s_lshl_b32 s58, s57, 4
  s_and_b32 s59, s6, 1
  s_lshl_b32 s59, s59, 2
  s_add_u32 s58, s58, s59
  v_add_u32 v4, s58, v4
  v_lshlrev_b32 v5, 3, v2
  v_sub_u32 v4, v4, v5
  s_cmp_eq_u32 s57, 0
  s_cselect_b32 s57, 8, 0
  v_mul_u32_u24 v2, s57, v2
  v_add_u32 v3, v3, v2
  v_subrev_u32 v3, 8, v3
  v_ashrrev_i32 v3, 31, v3
  v_bfi_b32 v19, v3, v4, 2.0
  s_barrier
  s_branch L_p2
L_compute:
  s_and_b32 s59, s3, 1
  s_lshr_b32 s60, s3, 1
  v_and_b32 v18, 15, v1
  v_lshrrev_b32 v19, 4, v1
  s_lshl_b32 s57, s59, 13
  v_lshl_add_u32 v10, v18, 7, s57
  v_and_b32 v11, 1, v19
  v_lshl_add_u32 v10, v11, 3, v10
  v_lshrrev_b32 v11, 1, v19
  v_lshrrev_b32 v12, 1, v18
  v_xor_b32 v11, v11, v12
  v_xor_b32 v12, 0, v11
  v_lshl_add_u32 v2, v12, 4, v10
  v_xor_b32 v12, 2, v11
  v_lshl_add_u32 v3, v12, 4, v10
  v_xor_b32 v12, 4, v11
  v_lshl_add_u32 v4, v12, 4, v10
  v_xor_b32 v12, 6, v11
  v_lshl_add_u32 v5, v12, 4, v10
  v_lshrrev_b32 v10, 2, v1
  v_mul_u32_u24 v10, 288, v10
  v_and_b32 v11, 3, v1
  s_mul_i32 s57, s60, 144
  s_add_u32 s57, s57, 16384
  v_lshl_add_u32 v6, v11, 3, v10
  v_add_u32 v6, s57, v6
  v_mul_u32_u24 v11, 72, v11
  v_add_u32 v7, v10, v11
  v_add_u32 v7, 16416, v7
  v_mov_b32 v8, v6
  v_mov_b32 v9, v7
  v_mov_b32 v64, 0
  v_mov_b32 v65, 0
  v_mov_b32 v66, 0
  v_mov_b32 v67, 0
  v_mov_b32 v68, 0
  v_mov_b32 v69, 0
  v_mov_b32 v70, 0
  v_mov_b32 v71, 0
  v_mov_b32 v72, 0
  v_mov_b32 v73, 0
  v_mov_b32 v74, 0
  v_mov_b32 v75, 0
  v_mov_b32 v76, 0
  v_mov_b32 v77, 0
  v_mov_b32 v78, 0
  v_mov_b32 v79, 0
  v_mov_b32 v80, 0
  v_mov_b32 v81, 0
  v_mov_b32 v82, 0
  v_mov_b32 v83, 0
  v_mov_b32 v84, 0
  v_mov_b32 v85, 0
  v_mov_b32 v86, 0
  v_mov_b32 v87, 0
  v_mov_b32 v88, 0
  v_mov_b32 v89, 0
  v_mov_b32 v90, 0
  v_mov_b32 v91, 0
  v_mov_b32 v92, 0
  v_mov_b32 v93, 0
  v_mov_b32 v94, 0
  v_mov_b32 v95, 0
  v_mov_b32 v96, 0
  v_mov_b32 v97, 0
  v_mov_b32 v98, 0
  v_mov_b32 v99, 0
  v_mov_b32 v100, 0
  v_mov_b32 v101, 0
  v_mov_b32 v102, 0
  v_mov_b32 v103, 0
  v_mov_b32 v104, 0
  v_mov_b32 v105, 0
  v_mov_b32 v106, 0
  v_mov_b32 v107, 0
  v_mov_b32 v108, 0
  v_mov_b32 v109, 0
  v_mov_b32 v110, 0
  v_mov_b32 v111, 0
  v_mov_b32 v112, 0
  v_mov_b32 v113, 0
  v_mov_b32 v114, 0
  v_mov_b32 v115, 0
  v_mov_b32 v116, 0
  v_mov_b32 v117, 0
  v_mov_b32 v118, 0
  v_mov_b32 v119, 0
  v_mov_b32 v120, 0
  v_mov_b32 v121, 0
  v_mov_b32 v122, 0
  v_mov_b32 v123, 0
  v_mov_b32 v124, 0
  v_mov_b32 v125, 0
  v_mov_b32 v126, 0
  v_mov_b32 v127, 0
  v_mov_b32 v128, 0
  v_mov_b32 v129, 0
  v_mov_b32 v130, 0
  v_mov_b32 v131, 0
  v_mov_b32 v132, 0
  v_mov_b32 v133, 0
  v_mov_b32 v134, 0
  v_mov_b32 v135, 0
  v_mov_b32 v136, 0
  v_mov_b32 v137, 0
  v_mov_b32 v138, 0
  v_mov_b32 v139, 0
  v_mov_b32 v140, 0
  v_mov_b32 v141, 0
  v_mov_b32 v142, 0
  v_mov_b32 v143, 0
  v_lshrrev_b32 v10, 1, v19
  v_lshlrev_b32 v13, 15, v10
  v_and_b32 v10, 1, v19
  v_lshl_add_u32 v13, v10, 8, v13
  v_lshl_add_u32 v13, v18, 4, v13
  v_lshlrev_b32 v14, 15, v19
  s_cmp_ge_u32 s7, 8
  s_cselect_b32 s57, 4, 3
  v_lshl_add_u32 v14, v18, s57, v14
  s_mov_b32 s10, 2359296
  s_mov_b32 s11, 0x20000
  s_mov_b32 s14, 1990656
  s_mov_b32 s15, 0x20000
  s_waitcnt lgkmcnt(0)
  s_or_b32 s57, s2, s3
  s_cmp_lg_u32 s57, 0
  s_cbranch_scc1 L_notag
  v_mov_b32 v21, 0
  s_or_b32 s66, s90, 1
  v_mov_b32 v20, s66
  s_mov_b64 exec, 1
  global_store_dword v21, v20, s[36:37] sc1
  s_mov_b64 exec, -1
L_notag:
  s_mov_b32 s40, s38
  s_mov_b32 s41, s39
  s_mov_b32 s42, 14680064
  s_mov_b32 s43, 0x20000
  s_mov_b32 s44, s34
  s_mov_b32 s45, s35
  s_mov_b32 s46, 2359296
  s_mov_b32 s47, 0x20000
  s_mov_b32 s81, 0
  s_mov_b32 s86, 0
  s_mov_b32 s62, 0
  s_mov_b32 s63, 0
  s_lshl_b32 s57, s6, 11
  s_lshl_b32 s58, s59, 10
  s_add_u32 s57, s57, s58
  s_lshl_b32 s64, s7, 3
  s_lshl_b32 s58, s60, 2
  s_add_u32 s64, s64, s58
  s_lshl_b32 s64, s64, 16
  s_add_u32 s64, s64, s57
  s_add_u32 s64, s64, 1048576
  s_lshl_b32 s65, s7, 17
  s_cmp_lt_u32 s7, 8
  s_cselect_b32 s58, 1, 0
  s_lshr_b32 s57, s57, s58
  s_add_u32 s65, s65, s57
  s_add_u32 s65, s65, 7340032
  s_mov_b32 s66, 1051597459
  s_mov_b32 s67, s66
  v_mov_b32 v37, 0x3f803f80
  v_mov_b32 v39, 0x3f803f80
  v_mov_b32 v41, 0x3f803f80
  v_mov_b32 v43, 0x3f803f80
  v_mov_b32 v45, 0x3f803f80
  v_mov_b32 v47, 0x3f803f80
  v_mov_b32 v49, 0x3f803f80
  v_mov_b32 v51, 0x3f803f80
  s_cmp_eq_u32 s3, 3
  s_cbranch_scc0 L_wm_1
  s_mov_b32 s40, s38
  s_mov_b32 s41, s39
  s_mov_b32 s42, 14680064
  s_mov_b32 s43, 0x20000
  s_lshr_b32 s88, s5, 2
  s_add_u32 s88, s88, 1
  s_and_b32 s88, s88, 7
  s_lshl_b32 s88, s88, 3
  s_add_u32 s88, s88, s4
  s_lshl_b32 s88, s88, 2
  s_and_b32 s89, s5, 3
  s_add_u32 s88, s88, s89
  s_lshl_b32 s88, s88, 7
  v_min_u32 v61, 9, v1
  v_lshlrev_b32 v61, 2, v61
  buffer_load_dword v62, v61, s[40:43], s88 offen sc1
  s_and_b32 s88, s4, 3
  s_lshl_b32 s88, s88, 1
  s_lshr_b32 s87, s4, 2
  s_add_u32 s88, s88, s87
  s_lshl_b32 s88, s88, 2
  s_add_u32 s88, s88, s89
  s_lshl_b32 s88, s88, 3
  s_lshr_b32 s89, s5, 2
  s_add_u32 s88, s88, s89
  s_lshl_b32 s88, s88, 7
  s_add_u32 s88, s88, 32768
  v_and_b32 v61, 31, v1
  v_lshlrev_b32 v61, 2, v61
  buffer_load_dword v62, v61, s[40:43], s88 offen sc1
L_wm_1:
  s_cmp_eq_u32 s3, 2
  s_cbranch_scc0 L_nowt
  s_mov_b32 s48, s20
  s_mov_b32 s49, s21
  s_mov_b32 s50, 663552
  s_mov_b32 s51, 0x20000
  s_lshl_b32 s57, s5, 3
  s_add_u32 s57, s57, s4
  s_mul_i32 s57, s57, 3456
  v_min_u32 v61, 26, v1
  v_lshlrev_b32 v61, 7, v61
  buffer_load_dword v62, v61, s[48:51], s57 offen
L_nowt:
  s_cmp_eq_u32 s60, 0
  s_cbranch_scc0 L_cmp4
  s_barrier
  ds_read_b64_tr_b16 v[160:161], v6 offset:0
  ds_read_b64_tr_b16 v[162:163], v6 offset:4608
  ds_read_b64 v[144:145], v2 offset:0
  ds_read_b64 v[146:147], v3 offset:0
  ds_read_b64 v[148:149], v2 offset:2048
  ds_read_b64 v[150:151], v3 offset:2048
  ds_read_b64 v[152:153], v2 offset:4096
  ds_read_b64 v[154:155], v3 offset:4096
  ds_read_b64 v[156:157], v2 offset:6144
  ds_read_b64 v[158:159], v3 offset:6144
  ds_read_b64_tr_b16 v[164:165], v6 offset:40
  ds_read_b64_tr_b16 v[166:167], v6 offset:4648
  ds_read_b64_tr_b16 v[168:169], v6 offset:72
  ds_read_b64_tr_b16 v[170:171], v6 offset:4680
  ds_read_b64_tr_b16 v[172:173], v6 offset:112
  ds_read_b64_tr_b16 v[174:175], v6 offset:4720
  ds_read_b64_tr_b16 v[176:177], v7 offset:0
  ds_read_b64_tr_b16 v[178:179], v7 offset:4608
  s_waitcnt lgkmcnt(0)
L_cloop0:
  v_mfma_f32_16x16x32_bf16 v[64:67], v[160:163], v[144:147], v[64:67]
  ds_read_b64_tr_b16 v[196:197], v8 offset:9216
  ds_read_b64_tr_b16 v[198:199], v8 offset:13824
  v_mfma_f32_16x16x32_bf16 v[68:71], v[160:163], v[148:151], v[68:71]
  ds_read_b64 v[180:181], v4 offset:0
  v_mfma_f32_16x16x32_bf16 v[72:75], v[160:163], v[152:155], v[72:75]
  ds_read_b64 v[182:183], v5 offset:0
  v_mfma_f32_16x16x32_bf16 v[76:79], v[160:163], v[156:159], v[76:79]
  ds_read_b64 v[184:185], v4 offset:2048
  ds_read_b64 v[186:187], v5 offset:2048
  v_mfma_f32_16x16x32_bf16 v[80:83], v[164:167], v[144:147], v[80:83]
  ds_read_b64 v[188:189], v4 offset:4096
  v_mfma_f32_16x16x32_bf16 v[84:87], v[164:167], v[148:151], v[84:87]
  ds_read_b64 v[190:191], v5 offset:4096
  s_add_u32 s63, s63, 1
  v_mfma_f32_16x16x32_bf16 v[88:91], v[164:167], v[152:155], v[88:91]
  ds_read_b64 v[192:193], v4 offset:6144
  s_cmp_eq_u32 s63, 4
  v_mfma_f32_16x16x32_bf16 v[92:95], v[164:167], v[156:159], v[92:95]
  ds_read_b64 v[194:195], v5 offset:6144
  ds_read_b64_tr_b16 v[200:201], v8 offset:9256
  v_mfma_f32_16x16x32_bf16 v[96:99], v[168:171], v[144:147], v[96:99]
  ds_read_b64_tr_b16 v[202:203], v8 offset:13864
  s_cselect_b32 s63, 0, s63
  v_mfma_f32_16x16x32_bf16 v[100:103], v[168:171], v[148:151], v[100:103]
  ds_read_b64_tr_b16 v[204:205], v8 offset:9288
  s_cselect_b32 s61, 4294828032, 0
  v_mfma_f32_16x16x32_bf16 v[104:107], v[168:171], v[152:155], v[104:107]
  ds_read_b64_tr_b16 v[206:207], v8 offset:13896
  ds_read_b64_tr_b16 v[208:209], v8 offset:9328
  v_mfma_f32_16x16x32_bf16 v[108:111], v[168:171], v[156:159], v[108:111]
  ds_read_b64_tr_b16 v[210:211], v8 offset:13936
  s_add_u32 s61, s61, 34816
  v_mfma_f32_16x16x32_bf16 v[112:115], v[172:175], v[144:147], v[112:115]
  ds_read_b64_tr_b16 v[212:213], v9 offset:9216
  v_add_u32 v2, s61, v2
  v_mfma_f32_16x16x32_bf16 v[116:119], v[172:175], v[148:151], v[116:119]
  ds_read_b64_tr_b16 v[214:215], v9 offset:13824
  v_add_u32 v3, s61, v3
  v_mfma_f32_16x16x32_bf16 v[120:123], v[172:175], v[152:155], v[120:123]
  v_add_u32 v6, s61, v6
  v_mfma_f32_16x16x32_bf16 v[124:127], v[172:175], v[156:159], v[124:127]
  v_add_u32 v7, s61, v7
  v_mfma_f32_16x16x32_bf16 v[128:131], v[176:179], v[144:147], v[128:131]
  s_waitcnt lgkmcnt(0)
  s_barrier
  v_mfma_f32_16x16x32_bf16 v[132:135], v[176:179], v[148:151], v[132:135]
  v_mfma_f32_16x16x32_bf16 v[64:67], v[196:199], v[180:183], v[64:67]
  ds_read_b64_tr_b16 v[160:161], v6 offset:0
  ds_read_b64_tr_b16 v[162:163], v6 offset:4608
  v_mfma_f32_16x16x32_bf16 v[68:71], v[196:199], v[184:187], v[68:71]
  ds_read_b64 v[144:145], v2 offset:0
  v_mfma_f32_16x16x32_bf16 v[72:75], v[196:199], v[188:191], v[72:75]
  ds_read_b64 v[146:147], v3 offset:0
  v_mfma_f32_16x16x32_bf16 v[76:79], v[196:199], v[192:195], v[76:79]
  ds_read_b64 v[148:149], v2 offset:2048
  ds_read_b64 v[150:151], v3 offset:2048
  v_mfma_f32_16x16x32_bf16 v[80:83], v[200:203], v[180:183], v[80:83]
  ds_read_b64 v[152:153], v2 offset:4096
  v_mfma_f32_16x16x32_bf16 v[84:87], v[200:203], v[184:187], v[84:87]
  ds_read_b64 v[154:155], v3 offset:4096
  v_mfma_f32_16x16x32_bf16 v[88:91], v[200:203], v[188:191], v[88:91]
  ds_read_b64 v[156:157], v2 offset:6144
  v_mfma_f32_16x16x32_bf16 v[92:95], v[200:203], v[192:195], v[92:95]
  ds_read_b64 v[158:159], v3 offset:6144
  ds_read_b64_tr_b16 v[164:165], v6 offset:40
  v_mfma_f32_16x16x32_bf16 v[96:99], v[204:207], v[180:183], v[96:99]
  ds_read_b64_tr_b16 v[166:167], v6 offset:4648
  v_mfma_f32_16x16x32_bf16 v[100:103], v[204:207], v[184:187], v[100:103]
  ds_read_b64_tr_b16 v[168:169], v6 offset:72
  v_add_u32 v4, s61, v4
  v_mfma_f32_16x16x32_bf16 v[104:107], v[204:207], v[188:191], v[104:107]
  ds_read_b64_tr_b16 v[170:171], v6 offset:4680
  ds_read_b64_tr_b16 v[172:173], v6 offset:112
  v_mfma_f32_16x16x32_bf16 v[108:111], v[204:207], v[192:195], v[108:111]
  ds_read_b64_tr_b16 v[174:175], v6 offset:4720
  v_add_u32 v5, s61, v5
  v_mfma_f32_16x16x32_bf16 v[112:115], v[208:211], v[180:183], v[112:115]
  ds_read_b64_tr_b16 v[176:177], v7 offset:0
  v_add_u32 v8, s61, v8
  v_mfma_f32_16x16x32_bf16 v[116:119], v[208:211], v[184:187], v[116:119]
  ds_read_b64_tr_b16 v[178:179], v7 offset:4608
  v_add_u32 v9, s61, v9
  v_mfma_f32_16x16x32_bf16 v[120:123], v[208:211], v[188:191], v[120:123]
  s_add_u32 s62, s62, 1
  v_mfma_f32_16x16x32_bf16 v[124:127], v[208:211], v[192:195], v[124:127]
  s_cmp_lt_u32 s62, 8
  v_mfma_f32_16x16x32_bf16 v[128:131], v[212:215], v[180:183], v[128:131]
  s_waitcnt lgkmcnt(0)
  v_mfma_f32_16x16x32_bf16 v[132:135], v[212:215], v[184:187], v[132:135]
  s_cbranch_scc1 L_cloop0
  v_mov_b32 v18, 0
  global_load_dword v17, v18, s[36:37] sc1
  v_mfma_f32_16x16x32_bf16 v[128:131], v[176:179], v[144:147], v[128:131]
  ds_read_b64_tr_b16 v[212:213], v9 offset:9216
  ds_read_b64_tr_b16 v[214:215], v9 offset:13824
  ds_read_b64 v[180:181], v4 offset:0
  v_mfma_f32_16x16x32_bf16 v[132:135], v[176:179], v[148:151], v[132:135]
  ds_read_b64 v[182:183], v5 offset:0
  ds_read_b64 v[184:185], v4 offset:2048
  ds_read_b64 v[186:187], v5 offset:2048
  v_mfma_f32_16x16x32_bf16 v[64:67], v[160:163], v[144:147], v[64:67]
  ds_read_b64 v[188:189], v4 offset:4096
  ds_read_b64 v[190:191], v5 offset:4096
  ds_read_b64 v[192:193], v4 offset:6144
  v_mfma_f32_16x16x32_bf16 v[68:71], v[160:163], v[148:151], v[68:71]
  ds_read_b64 v[194:195], v5 offset:6144
  ds_read_b64_tr_b16 v[196:197], v8 offset:9216
  ds_read_b64_tr_b16 v[198:199], v8 offset:13824
  v_mfma_f32_16x16x32_bf16 v[72:75], v[160:163], v[152:155], v[72:75]
  ds_read_b64_tr_b16 v[200:201], v8 offset:9256
  ds_read_b64_tr_b16 v[202:203], v8 offset:13864
  ds_read_b64_tr_b16 v[204:205], v8 offset:9288
  v_mfma_f32_16x16x32_bf16 v[76:79], v[160:163], v[156:159], v[76:79]
  ds_read_b64_tr_b16 v[206:207], v8 offset:13896
  ds_read_b64_tr_b16 v[208:209], v8 offset:9328
  ds_read_b64_tr_b16 v[210:211], v8 offset:13936
  s_waitcnt lgkmcnt(0)
  s_barrier
  v_mfma_f32_16x16x32_bf16 v[128:131], v[212:215], v[180:183], v[128:131]
  v_mfma_f32_16x16x32_bf16 v[132:135], v[212:215], v[184:187], v[132:135]
  v_mfma_f32_16x16x32_bf16 v[64:67], v[196:199], v[180:183], v[64:67]
  v_mfma_f32_16x16x32_bf16 v[68:71], v[196:199], v[184:187], v[68:71]
  v_mfma_f32_16x16x32_bf16 v[72:75], v[196:199], v[188:191], v[72:75]
  s_nop 1
  s_nop 3
  s_cmp_lt_u32 s7, 4
  s_cbranch_scc0 L_nosc_2
  v_pk_mul_f32 v[128:129], v[128:129], s[66:67]
  v_pk_mul_f32 v[130:131], v[130:131], s[66:67]
  v_pk_mul_f32 v[132:133], v[132:133], s[66:67]
  v_pk_mul_f32 v[134:135], v[134:135], s[66:67]
L_nosc_2:
  v_cvt_pk_bf16_f32 v36, v128, v129
  v_mfma_f32_16x16x32_bf16 v[76:79], v[196:199], v[192:195], v[76:79]
  s_cmp_ge_u32 s7, 8
  s_cbranch_scc0 L_x8_3
  v_cvt_pk_bf16_f32 v38, v130, v131
  buffer_store_dwordx4 v[36:39], v14, s[40:43], s65 offen offset:0 sc1
  s_branch L_xd_4
L_x8_3:
  v_cvt_pk_bf16_f32 v37, v130, v131
  buffer_store_dwordx2 v[36:37], v14, s[40:43], s65 offen offset:0 sc1
L_xd_4:
  v_cvt_pk_bf16_f32 v40, v132, v133
  s_cmp_ge_u32 s7, 8
  s_cbranch_scc0 L_x8_5
  v_cvt_pk_bf16_f32 v42, v134, v135
  buffer_store_dwordx4 v[40:43], v14, s[40:43], s65 offen offset:256 sc1
  s_branch L_xd_6
L_x8_5:
  v_cvt_pk_bf16_f32 v41, v134, v135
  buffer_store_dwordx2 v[40:41], v14, s[40:43], s65 offen offset:128 sc1
L_xd_6:
  v_mfma_f32_16x16x32_bf16 v[80:83], v[164:167], v[144:147], v[80:83]
  v_mfma_f32_16x16x32_bf16 v[84:87], v[164:167], v[148:151], v[84:87]
  v_mfma_f32_16x16x32_bf16 v[88:91], v[164:167], v[152:155], v[88:91]
  s_nop 3
  s_cmp_lt_u32 s7, 4
  s_cbranch_scc0 L_nosc_7
  v_pk_mul_f32 v[64:65], v[64:65], s[66:67]
  v_pk_mul_f32 v[66:67], v[66:67], s[66:67]
  v_pk_mul_f32 v[68:69], v[68:69], s[66:67]
  v_pk_mul_f32 v[70:71], v[70:71], s[66:67]
  v_pk_mul_f32 v[72:73], v[72:73], s[66:67]
  v_pk_mul_f32 v[74:75], v[74:75], s[66:67]
  v_pk_mul_f32 v[76:77], v[76:77], s[66:67]
  v_pk_mul_f32 v[78:79], v[78:79], s[66:67]
L_nosc_7:
  v_cvt_pk_bf16_f32 v28, v64, v65
  v_mfma_f32_16x16x32_bf16 v[92:95], v[164:167], v[156:159], v[92:95]
  v_cvt_pk_bf16_f32 v30, v68, v69
  v_cvt_pk_bf16_f32 v29, v66, v67
  v_cvt_pk_bf16_f32 v31, v70, v71
  v_mfma_f32_16x16x32_bf16 v[80:83], v[200:203], v[180:183], v[80:83]
  v_cvt_pk_bf16_f32 v32, v72, v73
  v_cvt_pk_bf16_f32 v34, v76, v77
  v_cvt_pk_bf16_f32 v33, v74, v75
  v_mfma_f32_16x16x32_bf16 v[84:87], v[200:203], v[184:187], v[84:87]
  v_cvt_pk_bf16_f32 v35, v78, v79
  v_permlane16_swap_b32 v28, v30
  v_permlane16_swap_b32 v29, v31
  v_mfma_f32_16x16x32_bf16 v[88:91], v[200:203], v[188:191], v[88:91]
  buffer_store_dwordx4 v[28:31], v13, s[40:43], s64 offen offset:0 sc1
  v_permlane16_swap_b32 v32, v34
  v_permlane16_swap_b32 v33, v35
  v_mfma_f32_16x16x32_bf16 v[92:95], v[200:203], v[192:195], v[92:95]
  buffer_store_dwordx4 v[32:35], v13, s[40:43], s64 offen offset:512 sc1
  s_add_u32 s64, s64, 65536
  v_mfma_f32_16x16x32_bf16 v[96:99], v[168:171], v[144:147], v[96:99]
  v_mfma_f32_16x16x32_bf16 v[100:103], v[168:171], v[148:151], v[100:103]
  v_mfma_f32_16x16x32_bf16 v[104:107], v[168:171], v[152:155], v[104:107]
  s_nop 3
  s_cmp_lt_u32 s7, 4
  s_cbranch_scc0 L_nosc_8
  v_pk_mul_f32 v[80:81], v[80:81], s[66:67]
  v_pk_mul_f32 v[82:83], v[82:83], s[66:67]
  v_pk_mul_f32 v[84:85], v[84:85], s[66:67]
  v_pk_mul_f32 v[86:87], v[86:87], s[66:67]
  v_pk_mul_f32 v[88:89], v[88:89], s[66:67]
  v_pk_mul_f32 v[90:91], v[90:91], s[66:67]
  v_pk_mul_f32 v[92:93], v[92:93], s[66:67]
  v_pk_mul_f32 v[94:95], v[94:95], s[66:67]
L_nosc_8:
  v_cvt_pk_bf16_f32 v20, v80, v81
  v_mfma_f32_16x16x32_bf16 v[108:111], v[168:171], v[156:159], v[108:111]
  v_cvt_pk_bf16_f32 v22, v84, v85
  v_cvt_pk_bf16_f32 v21, v82, v83
  v_cvt_pk_bf16_f32 v23, v86, v87
  v_mfma_f32_16x16x32_bf16 v[96:99], v[204:207], v[180:183], v[96:99]
  v_cvt_pk_bf16_f32 v24, v88, v89
  v_cvt_pk_bf16_f32 v26, v92, v93
  v_cvt_pk_bf16_f32 v25, v90, v91
  v_mfma_f32_16x16x32_bf16 v[100:103], v[204:207], v[184:187], v[100:103]
  v_cvt_pk_bf16_f32 v27, v94, v95
  v_permlane16_swap_b32 v20, v22
  v_permlane16_swap_b32 v21, v23
  v_mfma_f32_16x16x32_bf16 v[104:107], v[204:207], v[188:191], v[104:107]
  buffer_store_dwordx4 v[20:23], v13, s[40:43], s64 offen offset:0 sc1
  v_permlane16_swap_b32 v24, v26
  v_permlane16_swap_b32 v25, v27
  v_mfma_f32_16x16x32_bf16 v[108:111], v[204:207], v[192:195], v[108:111]
  buffer_store_dwordx4 v[24:27], v13, s[40:43], s64 offen offset:512 sc1
  s_add_u32 s64, s64, 65536
  v_mfma_f32_16x16x32_bf16 v[112:115], v[172:175], v[144:147], v[112:115]
  v_mfma_f32_16x16x32_bf16 v[116:119], v[172:175], v[148:151], v[116:119]
  v_mfma_f32_16x16x32_bf16 v[120:123], v[172:175], v[152:155], v[120:123]
  s_nop 3
  s_cmp_lt_u32 s7, 4
  s_cbranch_scc0 L_nosc_9
  v_pk_mul_f32 v[96:97], v[96:97], s[66:67]
  v_pk_mul_f32 v[98:99], v[98:99], s[66:67]
  v_pk_mul_f32 v[100:101], v[100:101], s[66:67]
  v_pk_mul_f32 v[102:103], v[102:103], s[66:67]
  v_pk_mul_f32 v[104:105], v[104:105], s[66:67]
  v_pk_mul_f32 v[106:107], v[106:107], s[66:67]
  v_pk_mul_f32 v[108:109], v[108:109], s[66:67]
  v_pk_mul_f32 v[110:111], v[110:111], s[66:67]
L_nosc_9:
  v_cvt_pk_bf16_f32 v28, v96, v97
  v_mfma_f32_16x16x32_bf16 v[124:127], v[172:175], v[156:159], v[124:127]
  v_cvt_pk_bf16_f32 v30, v100, v101
  v_cvt_pk_bf16_f32 v29, v98, v99
  v_cvt_pk_bf16_f32 v31, v102, v103
  v_mfma_f32_16x16x32_bf16 v[112:115], v[208:211], v[180:183], v[112:115]
  v_cvt_pk_bf16_f32 v32, v104, v105
  v_cvt_pk_bf16_f32 v34, v108, v109
  v_cvt_pk_bf16_f32 v33, v106, v107
  v_mfma_f32_16x16x32_bf16 v[116:119], v[208:211], v[184:187], v[116:119]
  v_cvt_pk_bf16_f32 v35, v110, v111
  v_permlane16_swap_b32 v28, v30
  v_permlane16_swap_b32 v29, v31
  v_mfma_f32_16x16x32_bf16 v[120:123], v[208:211], v[188:191], v[120:123]
  buffer_store_dwordx4 v[28:31], v13, s[40:43], s64 offen offset:0 sc1
  v_permlane16_swap_b32 v32, v34
  v_permlane16_swap_b32 v33, v35
  v_mfma_f32_16x16x32_bf16 v[124:127], v[208:211], v[192:195], v[124:127]
  buffer_store_dwordx4 v[32:35], v13, s[40:43], s64 offen offset:512 sc1
  s_add_u32 s64, s64, 65536
  s_nop 5
  s_nop 3
  s_cmp_lt_u32 s7, 4
  s_cbranch_scc0 L_nosc_10
  v_pk_mul_f32 v[112:113], v[112:113], s[66:67]
  v_pk_mul_f32 v[114:115], v[114:115], s[66:67]
  v_pk_mul_f32 v[116:117], v[116:117], s[66:67]
  v_pk_mul_f32 v[118:119], v[118:119], s[66:67]
  v_pk_mul_f32 v[120:121], v[120:121], s[66:67]
  v_pk_mul_f32 v[122:123], v[122:123], s[66:67]
  v_pk_mul_f32 v[124:125], v[124:125], s[66:67]
  v_pk_mul_f32 v[126:127], v[126:127], s[66:67]
L_nosc_10:
  v_cvt_pk_bf16_f32 v20, v112, v113
  v_cvt_pk_bf16_f32 v22, v116, v117
  v_cvt_pk_bf16_f32 v21, v114, v115
  v_cvt_pk_bf16_f32 v23, v118, v119
  v_cvt_pk_bf16_f32 v24, v120, v121
  v_cvt_pk_bf16_f32 v26, v124, v125
  v_cvt_pk_bf16_f32 v25, v122, v123
  v_cvt_pk_bf16_f32 v27, v126, v127
  v_permlane16_swap_b32 v20, v22
  v_permlane16_swap_b32 v21, v23
  buffer_store_dwordx4 v[20:23], v13, s[40:43], s64 offen offset:0 sc1
  v_permlane16_swap_b32 v24, v26
  v_permlane16_swap_b32 v25, v27
  buffer_store_dwordx4 v[24:27], v13, s[40:43], s64 offen offset:512 sc1
  s_add_u32 s64, s64, 65536
  s_branch L_cepi
L_cmp4:
  s_barrier
  ds_read_b64_tr_b16 v[160:161], v6 offset:0
  ds_read_b64_tr_b16 v[162:163], v6 offset:4608
  ds_read_b64 v[144:145], v2 offset:0
  ds_read_b64 v[146:147], v3 offset:0
  ds_read_b64 v[148:149], v2 offset:2048
  ds_read_b64 v[150:151], v3 offset:2048
  ds_read_b64 v[152:153], v2 offset:4096
  ds_read_b64 v[154:155], v3 offset:4096
  ds_read_b64 v[156:157], v2 offset:6144
  ds_read_b64 v[158:159], v3 offset:6144
  ds_read_b64_tr_b16 v[164:165], v6 offset:40
  ds_read_b64_tr_b16 v[166:167], v6 offset:4648
  ds_read_b64_tr_b16 v[168:169], v6 offset:72
  ds_read_b64_tr_b16 v[170:171], v6 offset:4680
  ds_read_b64_tr_b16 v[172:173], v6 offset:112
  ds_read_b64_tr_b16 v[174:175], v6 offset:4720
  ds_read_b64_tr_b16 v[176:177], v7 offset:0
  ds_read_b64_tr_b16 v[178:179], v7 offset:4608
  s_waitcnt lgkmcnt(0)
L_cloop1:
  v_mfma_f32_16x16x32_bf16 v[64:67], v[160:163], v[144:147], v[64:67]
  ds_read_b64_tr_b16 v[196:197], v8 offset:9216
  ds_read_b64_tr_b16 v[198:199], v8 offset:13824
  v_mfma_f32_16x16x32_bf16 v[68:71], v[160:163], v[148:151], v[68:71]
  ds_read_b64 v[180:181], v4 offset:0
  v_mfma_f32_16x16x32_bf16 v[72:75], v[160:163], v[152:155], v[72:75]
  ds_read_b64 v[182:183], v5 offset:0
  v_mfma_f32_16x16x32_bf16 v[76:79], v[160:163], v[156:159], v[76:79]
  ds_read_b64 v[184:185], v4 offset:2048
  ds_read_b64 v[186:187], v5 offset:2048
  v_mfma_f32_16x16x32_bf16 v[80:83], v[164:167], v[144:147], v[80:83]
  ds_read_b64 v[188:189], v4 offset:4096
  v_mfma_f32_16x16x32_bf16 v[84:87], v[164:167], v[148:151], v[84:87]
  ds_read_b64 v[190:191], v5 offset:4096
  s_add_u32 s63, s63, 1
  v_mfma_f32_16x16x32_bf16 v[88:91], v[164:167], v[152:155], v[88:91]
  ds_read_b64 v[192:193], v4 offset:6144
  s_cmp_eq_u32 s63, 4
  v_mfma_f32_16x16x32_bf16 v[92:95], v[164:167], v[156:159], v[92:95]
  ds_read_b64 v[194:195], v5 offset:6144
  ds_read_b64_tr_b16 v[200:201], v8 offset:9256
  v_mfma_f32_16x16x32_bf16 v[96:99], v[168:171], v[144:147], v[96:99]
  ds_read_b64_tr_b16 v[202:203], v8 offset:13864
  s_cselect_b32 s63, 0, s63
  v_mfma_f32_16x16x32_bf16 v[100:103], v[168:171], v[148:151], v[100:103]
  ds_read_b64_tr_b16 v[204:205], v8 offset:9288
  s_cselect_b32 s61, 4294828032, 0
  v_mfma_f32_16x16x32_bf16 v[104:107], v[168:171], v[152:155], v[104:107]
  ds_read_b64_tr_b16 v[206:207], v8 offset:13896
  ds_read_b64_tr_b16 v[208:209], v8 offset:9328
  v_mfma_f32_16x16x32_bf16 v[108:111], v[168:171], v[156:159], v[108:111]
  ds_read_b64_tr_b16 v[210:211], v8 offset:13936
  s_add_u32 s61, s61, 34816
  v_mfma_f32_16x16x32_bf16 v[112:115], v[172:175], v[144:147], v[112:115]
  ds_read_b64_tr_b16 v[212:213], v9 offset:9216
  v_add_u32 v2, s61, v2
  v_mfma_f32_16x16x32_bf16 v[116:119], v[172:175], v[148:151], v[116:119]
  ds_read_b64_tr_b16 v[214:215], v9 offset:13824
  v_add_u32 v3, s61, v3
  v_mfma_f32_16x16x32_bf16 v[120:123], v[172:175], v[152:155], v[120:123]
  v_add_u32 v6, s61, v6
  v_mfma_f32_16x16x32_bf16 v[124:127], v[172:175], v[156:159], v[124:127]
  v_add_u32 v7, s61, v7
  v_mfma_f32_16x16x32_bf16 v[136:139], v[176:179], v[152:155], v[136:139]
  s_waitcnt lgkmcnt(0)
  s_barrier
  v_mfma_f32_16x16x32_bf16 v[140:143], v[176:179], v[156:159], v[140:143]
  v_mfma_f32_16x16x32_bf16 v[64:67], v[196:199], v[180:183], v[64:67]
  ds_read_b64_tr_b16 v[160:161], v6 offset:0
  ds_read_b64_tr_b16 v[162:163], v6 offset:4608
  v_mfma_f32_16x16x32_bf16 v[68:71], v[196:199], v[184:187], v[68:71]
  ds_read_b64 v[144:145], v2 offset:0
  v_mfma_f32_16x16x32_bf16 v[72:75], v[196:199], v[188:191], v[72:75]
  ds_read_b64 v[146:147], v3 offset:0
  v_mfma_f32_16x16x32_bf16 v[76:79], v[196:199], v[192:195], v[76:79]
  ds_read_b64 v[148:149], v2 offset:2048
  ds_read_b64 v[150:151], v3 offset:2048
  v_mfma_f32_16x16x32_bf16 v[80:83], v[200:203], v[180:183], v[80:83]
  ds_read_b64 v[152:153], v2 offset:4096
  v_mfma_f32_16x16x32_bf16 v[84:87], v[200:203], v[184:187], v[84:87]
  ds_read_b64 v[154:155], v3 offset:4096
  v_mfma_f32_16x16x32_bf16 v[88:91], v[200:203], v[188:191], v[88:91]
  ds_read_b64 v[156:157], v2 offset:6144
  v_mfma_f32_16x16x32_bf16 v[92:95], v[200:203], v[192:195], v[92:95]
  ds_read_b64 v[158:159], v3 offset:6144
  ds_read_b64_tr_b16 v[164:165], v6 offset:40
  v_mfma_f32_16x16x32_bf16 v[96:99], v[204:207], v[180:183], v[96:99]
  ds_read_b64_tr_b16 v[166:167], v6 offset:4648
  v_mfma_f32_16x16x32_bf16 v[100:103], v[204:207], v[184:187], v[100:103]
  ds_read_b64_tr_b16 v[168:169], v6 offset:72
  v_add_u32 v4, s61, v4
  v_mfma_f32_16x16x32_bf16 v[104:107], v[204:207], v[188:191], v[104:107]
  ds_read_b64_tr_b16 v[170:171], v6 offset:4680
  ds_read_b64_tr_b16 v[172:173], v6 offset:112
  v_mfma_f32_16x16x32_bf16 v[108:111], v[204:207], v[192:195], v[108:111]
  ds_read_b64_tr_b16 v[174:175], v6 offset:4720
  v_add_u32 v5, s61, v5
  v_mfma_f32_16x16x32_bf16 v[112:115], v[208:211], v[180:183], v[112:115]
  ds_read_b64_tr_b16 v[176:177], v7 offset:0
  v_add_u32 v8, s61, v8
  v_mfma_f32_16x16x32_bf16 v[116:119], v[208:211], v[184:187], v[116:119]
  ds_read_b64_tr_b16 v[178:179], v7 offset:4608
  v_add_u32 v9, s61, v9
  v_mfma_f32_16x16x32_bf16 v[120:123], v[208:211], v[188:191], v[120:123]
  s_add_u32 s62, s62, 1
  v_mfma_f32_16x16x32_bf16 v[124:127], v[208:211], v[192:195], v[124:127]
  s_cmp_lt_u32 s62, 8
  v_mfma_f32_16x16x32_bf16 v[136:139], v[212:215], v[188:191], v[136:139]
  s_waitcnt lgkmcnt(0)
  v_mfma_f32_16x16x32_bf16 v[140:143], v[212:215], v[192:195], v[140:143]
  s_cbranch_scc1 L_cloop1
  v_mov_b32 v18, 0
  global_load_dword v17, v18, s[36:37] sc1
  v_mfma_f32_16x16x32_bf16 v[136:139], v[176:179], v[152:155], v[136:139]
  ds_read_b64_tr_b16 v[212:213], v9 offset:9216
  ds_read_b64_tr_b16 v[214:215], v9 offset:13824
  ds_read_b64 v[180:181], v4 offset:0
  v_mfma_f32_16x16x32_bf16 v[140:143], v[176:179], v[156:159], v[140:143]
  ds_read_b64 v[182:183], v5 offset:0
  ds_read_b64 v[184:185], v4 offset:2048
  ds_read_b64 v[186:187], v5 offset:2048
  v_mfma_f32_16x16x32_bf16 v[64:67], v[160:163], v[144:147], v[64:67]
  ds_read_b64 v[188:189], v4 offset:4096
  ds_read_b64 v[190:191], v5 offset:4096
  ds_read_b64 v[192:193], v4 offset:6144
  v_mfma_f32_16x16x32_bf16 v[68:71], v[160:163], v[148:151], v[68:71]
  ds_read_b64 v[194:195], v5 offset:6144
  ds_read_b64_tr_b16 v[196:197], v8 offset:9216
  ds_read_b64_tr_b16 v[198:199], v8 offset:13824
  v_mfma_f32_16x16x32_bf16 v[72:75], v[160:163], v[152:155], v[72:75]
  ds_read_b64_tr_b16 v[200:201], v8 offset:9256
  ds_read_b64_tr_b16 v[202:203], v8 offset:13864
  ds_read_b64_tr_b16 v[204:205], v8 offset:9288
  v_mfma_f32_16x16x32_bf16 v[76:79], v[160:163], v[156:159], v[76:79]
  ds_read_b64_tr_b16 v[206:207], v8 offset:13896
  ds_read_b64_tr_b16 v[208:209], v8 offset:9328
  ds_read_b64_tr_b16 v[210:211], v8 offset:13936
  s_waitcnt lgkmcnt(0)
  s_barrier
  v_mfma_f32_16x16x32_bf16 v[136:139], v[212:215], v[188:191], v[136:139]
  v_mfma_f32_16x16x32_bf16 v[140:143], v[212:215], v[192:195], v[140:143]
  v_mfma_f32_16x16x32_bf16 v[64:67], v[196:199], v[180:183], v[64:67]
  v_mfma_f32_16x16x32_bf16 v[68:71], v[196:199], v[184:187], v[68:71]
  v_mfma_f32_16x16x32_bf16 v[72:75], v[196:199], v[188:191], v[72:75]
  s_nop 1
  s_nop 3
  s_cmp_lt_u32 s7, 4
  s_cbranch_scc0 L_nosc_11
  v_pk_mul_f32 v[136:137], v[136:137], s[66:67]
  v_pk_mul_f32 v[138:139], v[138:139], s[66:67]
  v_pk_mul_f32 v[140:141], v[140:141], s[66:67]
  v_pk_mul_f32 v[142:143], v[142:143], s[66:67]
L_nosc_11:
  v_cvt_pk_bf16_f32 v44, v136, v137
  v_mfma_f32_16x16x32_bf16 v[76:79], v[196:199], v[192:195], v[76:79]
  s_cmp_ge_u32 s7, 8
  s_cbranch_scc0 L_x8_12
  v_cvt_pk_bf16_f32 v46, v138, v139
  buffer_store_dwordx4 v[44:47], v14, s[40:43], s65 offen offset:512 sc1
  s_branch L_xd_13
L_x8_12:
  v_cvt_pk_bf16_f32 v45, v138, v139
  buffer_store_dwordx2 v[44:45], v14, s[40:43], s65 offen offset:256 sc1
L_xd_13:
  v_cvt_pk_bf16_f32 v48, v140, v141
  s_cmp_ge_u32 s7, 8
  s_cbranch_scc0 L_x8_14
  v_cvt_pk_bf16_f32 v50, v142, v143
  buffer_store_dwordx4 v[48:51], v14, s[40:43], s65 offen offset:768 sc1
  s_branch L_xd_15
L_x8_14:
  v_cvt_pk_bf16_f32 v49, v142, v143
  buffer_store_dwordx2 v[48:49], v14, s[40:43], s65 offen offset:384 sc1
L_xd_15:
  v_mfma_f32_16x16x32_bf16 v[80:83], v[164:167], v[144:147], v[80:83]
  v_mfma_f32_16x16x32_bf16 v[84:87], v[164:167], v[148:151], v[84:87]
  v_mfma_f32_16x16x32_bf16 v[88:91], v[164:167], v[152:155], v[88:91]
  s_nop 3
  s_cmp_lt_u32 s7, 4
  s_cbranch_scc0 L_nosc_16
  v_pk_mul_f32 v[64:65], v[64:65], s[66:67]
  v_pk_mul_f32 v[66:67], v[66:67], s[66:67]
  v_pk_mul_f32 v[68:69], v[68:69], s[66:67]
  v_pk_mul_f32 v[70:71], v[70:71], s[66:67]
  v_pk_mul_f32 v[72:73], v[72:73], s[66:67]
  v_pk_mul_f32 v[74:75], v[74:75], s[66:67]
  v_pk_mul_f32 v[76:77], v[76:77], s[66:67]
  v_pk_mul_f32 v[78:79], v[78:79], s[66:67]
L_nosc_16:
  v_cvt_pk_bf16_f32 v28, v64, v65
  v_mfma_f32_16x16x32_bf16 v[92:95], v[164:167], v[156:159], v[92:95]
  v_cvt_pk_bf16_f32 v30, v68, v69
  v_cvt_pk_bf16_f32 v29, v66, v67
  v_cvt_pk_bf16_f32 v31, v70, v71
  v_mfma_f32_16x16x32_bf16 v[80:83], v[200:203], v[180:183], v[80:83]
  v_cvt_pk_bf16_f32 v32, v72, v73
  v_cvt_pk_bf16_f32 v34, v76, v77
  v_cvt_pk_bf16_f32 v33, v74, v75
  v_mfma_f32_16x16x32_bf16 v[84:87], v[200:203], v[184:187], v[84:87]
  v_cvt_pk_bf16_f32 v35, v78, v79
  v_permlane16_swap_b32 v28, v30
  v_permlane16_swap_b32 v29, v31
  v_mfma_f32_16x16x32_bf16 v[88:91], v[200:203], v[188:191], v[88:91]
  buffer_store_dwordx4 v[28:31], v13, s[40:43], s64 offen offset:0 sc1
  v_permlane16_swap_b32 v32, v34
  v_permlane16_swap_b32 v33, v35
  v_mfma_f32_16x16x32_bf16 v[92:95], v[200:203], v[192:195], v[92:95]
  buffer_store_dwordx4 v[32:35], v13, s[40:43], s64 offen offset:512 sc1
  s_add_u32 s64, s64, 65536
  v_mfma_f32_16x16x32_bf16 v[96:99], v[168:171], v[144:147], v[96:99]
  v_mfma_f32_16x16x32_bf16 v[100:103], v[168:171], v[148:151], v[100:103]
  v_mfma_f32_16x16x32_bf16 v[104:107], v[168:171], v[152:155], v[104:107]
  s_nop 3
  s_cmp_lt_u32 s7, 4
  s_cbranch_scc0 L_nosc_17
  v_pk_mul_f32 v[80:81], v[80:81], s[66:67]
  v_pk_mul_f32 v[82:83], v[82:83], s[66:67]
  v_pk_mul_f32 v[84:85], v[84:85], s[66:67]
  v_pk_mul_f32 v[86:87], v[86:87], s[66:67]
  v_pk_mul_f32 v[88:89], v[88:89], s[66:67]
  v_pk_mul_f32 v[90:91], v[90:91], s[66:67]
  v_pk_mul_f32 v[92:93], v[92:93], s[66:67]
  v_pk_mul_f32 v[94:95], v[94:95], s[66:67]
L_nosc_17:
  v_cvt_pk_bf16_f32 v20, v80, v81
  v_mfma_f32_16x16x32_bf16 v[108:111], v[168:171], v[156:159], v[108:111]
  v_cvt_pk_bf16_f32 v22, v84, v85
  v_cvt_pk_bf16_f32 v21, v82, v83
  v_cvt_pk_bf16_f32 v23, v86, v87
  v_mfma_f32_16x16x32_bf16 v[96:99], v[204:207], v[180:183], v[96:99]
  v_cvt_pk_bf16_f32 v24, v88, v89
  v_cvt_pk_bf16_f32 v26, v92, v93
  v_cvt_pk_bf16_f32 v25, v90, v91
  v_mfma_f32_16x16x32_bf16 v[100:103], v[204:207], v[184:187], v[100:103]
  v_cvt_pk_bf16_f32 v27, v94, v95
  v_permlane16_swap_b32 v20, v22
  v_permlane16_swap_b32 v21, v23
  v_mfma_f32_16x16x32_bf16 v[104:107], v[204:207], v[188:191], v[104:107]
  buffer_store_dwordx4 v[20:23], v13, s[40:43], s64 offen offset:0 sc1
  v_permlane16_swap_b32 v24, v26
  v_permlane16_swap_b32 v25, v27
  v_mfma_f32_16x16x32_bf16 v[108:111], v[204:207], v[192:195], v[108:111]
  buffer_store_dwordx4 v[24:27], v13, s[40:43], s64 offen offset:512 sc1
  s_add_u32 s64, s64, 65536
  v_mfma_f32_16x16x32_bf16 v[112:115], v[172:175], v[144:147], v[112:115]
  v_mfma_f32_16x16x32_bf16 v[116:119], v[172:175], v[148:151], v[116:119]
  v_mfma_f32_16x16x32_bf16 v[120:123], v[172:175], v[152:155], v[120:123]
  s_nop 3
  s_cmp_lt_u32 s7, 4
  s_cbranch_scc0 L_nosc_18
  v_pk_mul_f32 v[96:97], v[96:97], s[66:67]
  v_pk_mul_f32 v[98:99], v[98:99], s[66:67]
  v_pk_mul_f32 v[100:101], v[100:101], s[66:67]
  v_pk_mul_f32 v[102:103], v[102:103], s[66:67]
  v_pk_mul_f32 v[104:105], v[104:105], s[66:67]
  v_pk_mul_f32 v[106:107], v[106:107], s[66:67]
  v_pk_mul_f32 v[108:109], v[108:109], s[66:67]
  v_pk_mul_f32 v[110:111], v[110:111], s[66:67]
L_nosc_18:
  v_cvt_pk_bf16_f32 v28, v96, v97
  v_mfma_f32_16x16x32_bf16 v[124:127], v[172:175], v[156:159], v[124:127]
  v_cvt_pk_bf16_f32 v30, v100, v101
  v_cvt_pk_bf16_f32 v29, v98, v99
  v_cvt_pk_bf16_f32 v31, v102, v103
  v_mfma_f32_16x16x32_bf16 v[112:115], v[208:211], v[180:183], v[112:115]
  v_cvt_pk_bf16_f32 v32, v104, v105
  v_cvt_pk_bf16_f32 v34, v108, v109
  v_cvt_pk_bf16_f32 v33, v106, v107
  v_mfma_f32_16x16x32_bf16 v[116:119], v[208:211], v[184:187], v[116:119]
  v_cvt_pk_bf16_f32 v35, v110, v111
  v_permlane16_swap_b32 v28, v30
  v_permlane16_swap_b32 v29, v31
  v_mfma_f32_16x16x32_bf16 v[120:123], v[208:211], v[188:191], v[120:123]
  buffer_store_dwordx4 v[28:31], v13, s[40:43], s64 offen offset:0 sc1
  v_permlane16_swap_b32 v32, v34
  v_permlane16_swap_b32 v33, v35
  v_mfma_f32_16x16x32_bf16 v[124:127], v[208:211], v[192:195], v[124:127]
  buffer_store_dwordx4 v[32:35], v13, s[40:43], s64 offen offset:512 sc1
  s_add_u32 s64, s64, 65536
  s_nop 5
  s_nop 3
  s_cmp_lt_u32 s7, 4
  s_cbranch_scc0 L_nosc_19
  v_pk_mul_f32 v[112:113], v[112:113], s[66:67]
  v_pk_mul_f32 v[114:115], v[114:115], s[66:67]
  v_pk_mul_f32 v[116:117], v[116:117], s[66:67]
  v_pk_mul_f32 v[118:119], v[118:119], s[66:67]
  v_pk_mul_f32 v[120:121], v[120:121], s[66:67]
  v_pk_mul_f32 v[122:123], v[122:123], s[66:67]
  v_pk_mul_f32 v[124:125], v[124:125], s[66:67]
  v_pk_mul_f32 v[126:127], v[126:127], s[66:67]
L_nosc_19:
  v_cvt_pk_bf16_f32 v20, v112, v113
  v_cvt_pk_bf16_f32 v22, v116, v117
  v_cvt_pk_bf16_f32 v21, v114, v115
  v_cvt_pk_bf16_f32 v23, v118, v119
  v_cvt_pk_bf16_f32 v24, v120, v121
  v_cvt_pk_bf16_f32 v26, v124, v125
  v_cvt_pk_bf16_f32 v25, v122, v123
  v_cvt_pk_bf16_f32 v27, v126, v127
  v_permlane16_swap_b32 v20, v22
  v_permlane16_swap_b32 v21, v23
  buffer_store_dwordx4 v[20:23], v13, s[40:43], s64 offen offset:0 sc1
  v_permlane16_swap_b32 v24, v26
  v_permlane16_swap_b32 v25, v27
  buffer_store_dwordx4 v[24:27], v13, s[40:43], s64 offen offset:512 sc1
  s_add_u32 s64, s64, 65536
L_cepi:
  s_waitcnt vmcnt(0)
  v_mov_b32 v12, 160512
  v_mov_b32 v13, 1
  s_mov_b64 exec, 1
  ds_add_u32 v12, v13
  s_mov_b64 exec, -1
  s_branch L_p2
L_sphase:
  s_mov_b32 s81, 8
  s_lshl_b32 s6, s4, 3
  s_add_u32 s57, s5, 0
  s_and_b32 s57, s57, 7
  s_add_u32 s6, s6, s57
  v_lshrrev_b32 v7, 3, v1
  v_mul_u32_u24 v6, 9216, v7
  v_and_b32 v8, 7, v1
  v_lshl_add_u32 v6, v8, 4, v6
  v_lshlrev_b32 v7, 1, v7
  v_add_u32 v7, 40960, v7
  v_mov_b32 v8, 160512
  v_mov_b32 v10, 4
  v_mov_b32 v11, 0
  ds_write_b64 v8, v[10:11]
  v_mov_b32 v10, 0
  ds_write_b32 v8, v11 offset:12
  ds_write_b64 v8, v[10:11] offset:16
  ds_write_b64 v8, v[10:11] offset:24
  s_cmp_lt_u32 s3, 2
  s_cbranch_scc1 L_s_ctl
  s_sub_u32 s59, s3, 2
  s_cmp_ge_u32 s59, 3
  s_cselect_b32 s60, 3, 0
  s_sub_u32 s60, s59, s60
  s_mov_b32 s61, s60
  s_and_b32 s57, s6, 7
  s_mul_i32 s57, s57, 72
  s_mul_i32 s60, s60, 24
  s_add_u32 s60, s60, s57
  s_lshl_b32 s57, s60, 1
  s_add_u32 s57, s57, 40960
  v_mov_b32 v89, s57
  s_mul_i32 s60, s60, 9216
  s_lshl_b32 s57, s4, 10
  s_add_u32 s60, s60, s57
  v_lshlrev_b32 v6, 4, v1
  s_cmp_eq_u32 s3, 2
  s_cbranch_scc0 L_nocpf
  s_getpc_b64 s[62:63]
L_pc:
  s_sub_u32 s62, s62, L_pc-gated_mix__sliding_block__moe_arch_mod__prompt_kernel
  s_subb_u32 s63, s63, 0
  s_and_b32 s57, s6, 7
  s_lshl_b32 s57, s57, 5
  v_and_b32 v2, 31, v1
  v_add_u32 v2, s57, v2
  v_lshlrev_b32 v2, 7, v2
  v_min_u32 v2, L_end-gated_mix__sliding_block__moe_arch_mod__prompt_kernel, v2
  global_load_dword v60, v2, s[62:63]
L_nocpf:
  s_mov_b32 s10, 2359296
  s_mov_b32 s11, 0x20000
  s_mov_b32 s14, 1990656
  s_mov_b32 s15, 0x20000
  s_waitcnt lgkmcnt(0)
  s_cmp_eq_u32 s3, 7
  s_cbranch_scc0 L_wm_20
  s_mov_b32 s40, s38
  s_mov_b32 s41, s39
  s_mov_b32 s42, 14680064
  s_mov_b32 s43, 0x20000
  s_lshr_b32 s88, s5, 2
  s_add_u32 s88, s88, 1
  s_and_b32 s88, s88, 7
  s_lshl_b32 s88, s88, 3
  s_add_u32 s88, s88, s4
  s_lshl_b32 s88, s88, 2
  s_and_b32 s89, s5, 3
  s_add_u32 s88, s88, s89
  s_lshl_b32 s88, s88, 7
  v_min_u32 v61, 9, v1
  v_lshlrev_b32 v61, 2, v61
  buffer_load_dword v62, v61, s[40:43], s88 offen sc1
  s_and_b32 s88, s4, 3
  s_lshl_b32 s88, s88, 1
  s_lshr_b32 s87, s4, 2
  s_add_u32 s88, s88, s87
  s_lshl_b32 s88, s88, 2
  s_add_u32 s88, s88, s89
  s_lshl_b32 s88, s88, 3
  s_lshr_b32 s89, s5, 2
  s_add_u32 s88, s88, s89
  s_lshl_b32 s88, s88, 7
  s_add_u32 s88, s88, 32768
  v_and_b32 v61, 31, v1
  v_lshlrev_b32 v61, 2, v61
  buffer_load_dword v62, v61, s[40:43], s88 offen sc1
L_wm_20:
  s_barrier
  s_cmp_ge_u32 s59, 3
  s_cselect_b32 s12, s28, s26
  s_cselect_b32 s13, s29, s27
  s_mov_b32 s14, 5308416
  s_mov_b32 s95, s60
  s_lshl_b32 s57, s59, 11
  s_add_u32 s57, s57, 43008
  v_lshl_add_u32 v90, v1, 5, s57
  v_mov_b32 v88, v6
  buffer_load_dwordx4 v[156:159], v88, s[12:15], s95 offen nt
  s_add_u32 s95, s95, 9216
  buffer_load_dwordx4 v[160:163], v88, s[12:15], s95 offen nt
  s_add_u32 s95, s95, 9216
  buffer_load_dwordx4 v[164:167], v88, s[12:15], s95 offen nt
  s_add_u32 s95, s95, 9216
  buffer_load_dwordx4 v[168:171], v88, s[12:15], s95 offen nt
  s_add_u32 s95, s95, 9216
  buffer_load_dwordx4 v[172:175], v88, s[12:15], s95 offen nt
  s_add_u32 s95, s95, 9216
  buffer_load_dwordx4 v[176:179], v88, s[12:15], s95 offen nt
  s_add_u32 s95, s95, 9216
  buffer_load_dwordx4 v[180:183], v88, s[12:15], s95 offen nt
  s_add_u32 s95, s95, 9216
  s_mov_b32 s40, s38
  s_mov_b32 s41, s39
  s_mov_b32 s42, 14680064
  s_mov_b32 s43, 0x20000
  s_mov_b32 s44, s34
  s_mov_b32 s45, s35
  s_mov_b32 s46, 2359296
  s_mov_b32 s47, 0x20000
  s_mov_b32 s86, 1
  s_branch L_p2
L_prepret1:
  s_waitcnt vmcnt(5)
  buffer_load_dwordx4 v[184:187], v88, s[12:15], s95 offen nt
  s_add_u32 s95, s95, 9216
  s_waitcnt vmcnt(5)
  buffer_load_dwordx4 v[188:191], v88, s[12:15], s95 offen nt
  s_add_u32 s95, s95, 9216
  s_waitcnt vmcnt(5)
  buffer_load_dwordx4 v[192:195], v88, s[12:15], s95 offen nt
  s_add_u32 s95, s95, 9216
  s_waitcnt vmcnt(5)
  buffer_load_dwordx4 v[196:199], v88, s[12:15], s95 offen nt
  s_add_u32 s95, s95, 9216
  s_waitcnt vmcnt(5)
  buffer_load_dwordx4 v[200:203], v88, s[12:15], s95 offen nt
  s_add_u32 s95, s95, 9216
  s_waitcnt vmcnt(5)
  buffer_load_dwordx4 v[204:207], v88, s[12:15], s95 offen nt
  s_add_u32 s95, s95, 9216
  s_waitcnt vmcnt(5)
  buffer_load_dwordx4 v[208:211], v88, s[12:15], s95 offen nt
  s_add_u32 s95, s95, 9216
  s_waitcnt vmcnt(5)
  buffer_load_dwordx4 v[212:215], v88, s[12:15], s95 offen nt
  s_add_u32 s95, s95, 9216
  s_waitcnt vmcnt(5)
  buffer_load_dwordx4 v[216:219], v88, s[12:15], s95 offen nt
  s_add_u32 s95, s95, 9216
  s_waitcnt vmcnt(5)
  buffer_load_dwordx4 v[220:223], v88, s[12:15], s95 offen nt
  s_add_u32 s95, s95, 9216
  s_waitcnt vmcnt(5)
  buffer_load_dwordx4 v[224:227], v88, s[12:15], s95 offen nt
  s_add_u32 s95, s95, 9216
  s_waitcnt vmcnt(5)
  buffer_load_dwordx4 v[228:231], v88, s[12:15], s95 offen nt
  s_add_u32 s95, s95, 9216
  s_waitcnt vmcnt(5)
  buffer_load_dwordx4 v[232:235], v88, s[12:15], s95 offen nt
  s_add_u32 s95, s95, 9216
  s_waitcnt vmcnt(5)
  buffer_load_dwordx4 v[236:239], v88, s[12:15], s95 offen nt
  s_add_u32 s95, s95, 9216
  s_waitcnt vmcnt(5)
  buffer_load_dwordx4 v[240:243], v88, s[12:15], s95 offen nt
  s_add_u32 s95, s95, 9216
  s_waitcnt vmcnt(5)
  buffer_load_dwordx4 v[244:247], v88, s[12:15], s95 offen nt
  s_add_u32 s95, s95, 9216
  s_waitcnt vmcnt(5)
  buffer_load_dwordx4 v[248:251], v88, s[12:15], s95 offen nt
  v_mov_b32 v18, 0
  global_load_dword v17, v18, s[36:37] sc1
  s_barrier
  ds_read_u16 v64, v89 offset:0
  ds_read_u16 v65, v89 offset:2
  ds_read_u16 v66, v89 offset:4
  ds_read_u16 v67, v89 offset:6
  ds_read_u16 v68, v89 offset:8
  ds_read_u16 v69, v89 offset:10
  ds_read_u16 v70, v89 offset:12
  ds_read_u16 v71, v89 offset:14
  ds_read_u16 v72, v89 offset:16
  ds_read_u16 v73, v89 offset:18
  ds_read_u16 v74, v89 offset:20
  ds_read_u16 v75, v89 offset:22
  s_waitcnt lgkmcnt(0)
  ds_read_u16 v76, v89 offset:24
  ds_read_u16 v77, v89 offset:26
  ds_read_u16 v78, v89 offset:28
  ds_read_u16 v79, v89 offset:30
  ds_read_u16 v80, v89 offset:32
  ds_read_u16 v81, v89 offset:34
  ds_read_u16 v82, v89 offset:36
  ds_read_u16 v83, v89 offset:38
  ds_read_u16 v84, v89 offset:40
  ds_read_u16 v85, v89 offset:42
  ds_read_u16 v86, v89 offset:44
  ds_read_u16 v87, v89 offset:46
  v_mov_b32 v20, 0
  v_mov_b32 v21, 0
  v_mov_b32 v22, 0
  v_mov_b32 v23, 0
  v_mov_b32 v24, 0
  v_mov_b32 v25, 0
  v_mov_b32 v26, 0
  v_mov_b32 v27, 0
  s_waitcnt lgkmcnt(0)
  s_waitcnt vmcnt(22)
  v_lshlrev_b32 v28, 16, v64
  v_dot2_f32_bf16 v20, v156, v64, v20
  v_dot2_f32_bf16 v22, v157, v64, v22
  v_dot2_f32_bf16 v24, v158, v64, v24
  v_dot2_f32_bf16 v26, v159, v64, v26
  v_dot2_f32_bf16 v21, v156, v28, v21
  v_dot2_f32_bf16 v23, v157, v28, v23
  v_dot2_f32_bf16 v25, v158, v28, v25
  v_dot2_f32_bf16 v27, v159, v28, v27
  v_lshlrev_b32 v28, 16, v65
  v_dot2_f32_bf16 v20, v160, v65, v20
  v_dot2_f32_bf16 v22, v161, v65, v22
  v_dot2_f32_bf16 v24, v162, v65, v24
  v_dot2_f32_bf16 v26, v163, v65, v26
  v_dot2_f32_bf16 v21, v160, v28, v21
  v_dot2_f32_bf16 v23, v161, v28, v23
  v_dot2_f32_bf16 v25, v162, v28, v25
  v_dot2_f32_bf16 v27, v163, v28, v27
  v_lshlrev_b32 v28, 16, v66
  v_dot2_f32_bf16 v20, v164, v66, v20
  v_dot2_f32_bf16 v22, v165, v66, v22
  v_dot2_f32_bf16 v24, v166, v66, v24
  v_dot2_f32_bf16 v26, v167, v66, v26
  v_dot2_f32_bf16 v21, v164, v28, v21
  v_dot2_f32_bf16 v23, v165, v28, v23
  v_dot2_f32_bf16 v25, v166, v28, v25
  v_dot2_f32_bf16 v27, v167, v28, v27
  s_waitcnt vmcnt(19)
  v_lshlrev_b32 v28, 16, v67
  v_dot2_f32_bf16 v20, v168, v67, v20
  v_dot2_f32_bf16 v22, v169, v67, v22
  v_dot2_f32_bf16 v24, v170, v67, v24
  v_dot2_f32_bf16 v26, v171, v67, v26
  v_dot2_f32_bf16 v21, v168, v28, v21
  v_dot2_f32_bf16 v23, v169, v28, v23
  v_dot2_f32_bf16 v25, v170, v28, v25
  v_dot2_f32_bf16 v27, v171, v28, v27
  v_lshlrev_b32 v28, 16, v68
  v_dot2_f32_bf16 v20, v172, v68, v20
  v_dot2_f32_bf16 v22, v173, v68, v22
  v_dot2_f32_bf16 v24, v174, v68, v24
  v_dot2_f32_bf16 v26, v175, v68, v26
  v_dot2_f32_bf16 v21, v172, v28, v21
  v_dot2_f32_bf16 v23, v173, v28, v23
  v_dot2_f32_bf16 v25, v174, v28, v25
  v_dot2_f32_bf16 v27, v175, v28, v27
  v_lshlrev_b32 v28, 16, v69
  v_dot2_f32_bf16 v20, v176, v69, v20
  v_dot2_f32_bf16 v22, v177, v69, v22
  v_dot2_f32_bf16 v24, v178, v69, v24
  v_dot2_f32_bf16 v26, v179, v69, v26
  v_dot2_f32_bf16 v21, v176, v28, v21
  v_dot2_f32_bf16 v23, v177, v28, v23
  v_dot2_f32_bf16 v25, v178, v28, v25
  v_dot2_f32_bf16 v27, v179, v28, v27
  s_waitcnt vmcnt(16)
  v_lshlrev_b32 v28, 16, v70
  v_dot2_f32_bf16 v20, v180, v70, v20
  v_dot2_f32_bf16 v22, v181, v70, v22
  v_dot2_f32_bf16 v24, v182, v70, v24
  v_dot2_f32_bf16 v26, v183, v70, v26
  v_dot2_f32_bf16 v21, v180, v28, v21
  v_dot2_f32_bf16 v23, v181, v28, v23
  v_dot2_f32_bf16 v25, v182, v28, v25
  v_dot2_f32_bf16 v27, v183, v28, v27
  v_lshlrev_b32 v28, 16, v71
  v_dot2_f32_bf16 v20, v184, v71, v20
  v_dot2_f32_bf16 v22, v185, v71, v22
  v_dot2_f32_bf16 v24, v186, v71, v24
  v_dot2_f32_bf16 v26, v187, v71, v26
  v_dot2_f32_bf16 v21, v184, v28, v21
  v_dot2_f32_bf16 v23, v185, v28, v23
  v_dot2_f32_bf16 v25, v186, v28, v25
  v_dot2_f32_bf16 v27, v187, v28, v27
  v_lshlrev_b32 v28, 16, v72
  v_dot2_f32_bf16 v20, v188, v72, v20
  v_dot2_f32_bf16 v22, v189, v72, v22
  v_dot2_f32_bf16 v24, v190, v72, v24
  v_dot2_f32_bf16 v26, v191, v72, v26
  v_dot2_f32_bf16 v21, v188, v28, v21
  v_dot2_f32_bf16 v23, v189, v28, v23
  v_dot2_f32_bf16 v25, v190, v28, v25
  v_dot2_f32_bf16 v27, v191, v28, v27
  s_waitcnt vmcnt(13)
  v_lshlrev_b32 v28, 16, v73
  v_dot2_f32_bf16 v20, v192, v73, v20
  v_dot2_f32_bf16 v22, v193, v73, v22
  v_dot2_f32_bf16 v24, v194, v73, v24
  v_dot2_f32_bf16 v26, v195, v73, v26
  v_dot2_f32_bf16 v21, v192, v28, v21
  v_dot2_f32_bf16 v23, v193, v28, v23
  v_dot2_f32_bf16 v25, v194, v28, v25
  v_dot2_f32_bf16 v27, v195, v28, v27
  v_lshlrev_b32 v28, 16, v74
  v_dot2_f32_bf16 v20, v196, v74, v20
  v_dot2_f32_bf16 v22, v197, v74, v22
  v_dot2_f32_bf16 v24, v198, v74, v24
  v_dot2_f32_bf16 v26, v199, v74, v26
  v_dot2_f32_bf16 v21, v196, v28, v21
  v_dot2_f32_bf16 v23, v197, v28, v23
  v_dot2_f32_bf16 v25, v198, v28, v25
  v_dot2_f32_bf16 v27, v199, v28, v27
  v_lshlrev_b32 v28, 16, v75
  v_dot2_f32_bf16 v20, v200, v75, v20
  v_dot2_f32_bf16 v22, v201, v75, v22
  v_dot2_f32_bf16 v24, v202, v75, v24
  v_dot2_f32_bf16 v26, v203, v75, v26
  v_dot2_f32_bf16 v21, v200, v28, v21
  v_dot2_f32_bf16 v23, v201, v28, v23
  v_dot2_f32_bf16 v25, v202, v28, v25
  v_dot2_f32_bf16 v27, v203, v28, v27
  s_waitcnt vmcnt(10)
  v_lshlrev_b32 v28, 16, v76
  v_dot2_f32_bf16 v20, v204, v76, v20
  v_dot2_f32_bf16 v22, v205, v76, v22
  v_dot2_f32_bf16 v24, v206, v76, v24
  v_dot2_f32_bf16 v26, v207, v76, v26
  v_dot2_f32_bf16 v21, v204, v28, v21
  v_dot2_f32_bf16 v23, v205, v28, v23
  v_dot2_f32_bf16 v25, v206, v28, v25
  v_dot2_f32_bf16 v27, v207, v28, v27
  v_lshlrev_b32 v28, 16, v77
  v_dot2_f32_bf16 v20, v208, v77, v20
  v_dot2_f32_bf16 v22, v209, v77, v22
  v_dot2_f32_bf16 v24, v210, v77, v24
  v_dot2_f32_bf16 v26, v211, v77, v26
  v_dot2_f32_bf16 v21, v208, v28, v21
  v_dot2_f32_bf16 v23, v209, v28, v23
  v_dot2_f32_bf16 v25, v210, v28, v25
  v_dot2_f32_bf16 v27, v211, v28, v27
  v_lshlrev_b32 v28, 16, v78
  v_dot2_f32_bf16 v20, v212, v78, v20
  v_dot2_f32_bf16 v22, v213, v78, v22
  v_dot2_f32_bf16 v24, v214, v78, v24
  v_dot2_f32_bf16 v26, v215, v78, v26
  v_dot2_f32_bf16 v21, v212, v28, v21
  v_dot2_f32_bf16 v23, v213, v28, v23
  v_dot2_f32_bf16 v25, v214, v28, v25
  v_dot2_f32_bf16 v27, v215, v28, v27
  s_waitcnt vmcnt(7)
  v_lshlrev_b32 v28, 16, v79
  v_dot2_f32_bf16 v20, v216, v79, v20
  v_dot2_f32_bf16 v22, v217, v79, v22
  v_dot2_f32_bf16 v24, v218, v79, v24
  v_dot2_f32_bf16 v26, v219, v79, v26
  v_dot2_f32_bf16 v21, v216, v28, v21
  v_dot2_f32_bf16 v23, v217, v28, v23
  v_dot2_f32_bf16 v25, v218, v28, v25
  v_dot2_f32_bf16 v27, v219, v28, v27
  v_lshlrev_b32 v28, 16, v80
  v_dot2_f32_bf16 v20, v220, v80, v20
  v_dot2_f32_bf16 v22, v221, v80, v22
  v_dot2_f32_bf16 v24, v222, v80, v24
  v_dot2_f32_bf16 v26, v223, v80, v26
  v_dot2_f32_bf16 v21, v220, v28, v21
  v_dot2_f32_bf16 v23, v221, v28, v23
  v_dot2_f32_bf16 v25, v222, v28, v25
  v_dot2_f32_bf16 v27, v223, v28, v27
  v_lshlrev_b32 v28, 16, v81
  v_dot2_f32_bf16 v20, v224, v81, v20
  v_dot2_f32_bf16 v22, v225, v81, v22
  v_dot2_f32_bf16 v24, v226, v81, v24
  v_dot2_f32_bf16 v26, v227, v81, v26
  v_dot2_f32_bf16 v21, v224, v28, v21
  v_dot2_f32_bf16 v23, v225, v28, v23
  v_dot2_f32_bf16 v25, v226, v28, v25
  v_dot2_f32_bf16 v27, v227, v28, v27
  s_waitcnt vmcnt(4)
  v_lshlrev_b32 v28, 16, v82
  v_dot2_f32_bf16 v20, v228, v82, v20
  v_dot2_f32_bf16 v22, v229, v82, v22
  v_dot2_f32_bf16 v24, v230, v82, v24
  v_dot2_f32_bf16 v26, v231, v82, v26
  v_dot2_f32_bf16 v21, v228, v28, v21
  v_dot2_f32_bf16 v23, v229, v28, v23
  v_dot2_f32_bf16 v25, v230, v28, v25
  v_dot2_f32_bf16 v27, v231, v28, v27
  v_lshlrev_b32 v28, 16, v83
  v_dot2_f32_bf16 v20, v232, v83, v20
  v_dot2_f32_bf16 v22, v233, v83, v22
  v_dot2_f32_bf16 v24, v234, v83, v24
  v_dot2_f32_bf16 v26, v235, v83, v26
  v_dot2_f32_bf16 v21, v232, v28, v21
  v_dot2_f32_bf16 v23, v233, v28, v23
  v_dot2_f32_bf16 v25, v234, v28, v25
  v_dot2_f32_bf16 v27, v235, v28, v27
  v_lshlrev_b32 v28, 16, v84
  v_dot2_f32_bf16 v20, v236, v84, v20
  v_dot2_f32_bf16 v22, v237, v84, v22
  v_dot2_f32_bf16 v24, v238, v84, v24
  v_dot2_f32_bf16 v26, v239, v84, v26
  v_dot2_f32_bf16 v21, v236, v28, v21
  v_dot2_f32_bf16 v23, v237, v28, v23
  v_dot2_f32_bf16 v25, v238, v28, v25
  v_dot2_f32_bf16 v27, v239, v28, v27
  s_waitcnt vmcnt(1)
  v_lshlrev_b32 v28, 16, v85
  v_dot2_f32_bf16 v20, v240, v85, v20
  v_dot2_f32_bf16 v22, v241, v85, v22
  v_dot2_f32_bf16 v24, v242, v85, v24
  v_dot2_f32_bf16 v26, v243, v85, v26
  v_dot2_f32_bf16 v21, v240, v28, v21
  v_dot2_f32_bf16 v23, v241, v28, v23
  v_dot2_f32_bf16 v25, v242, v28, v25
  v_dot2_f32_bf16 v27, v243, v28, v27
  v_lshlrev_b32 v28, 16, v86
  v_dot2_f32_bf16 v20, v244, v86, v20
  v_dot2_f32_bf16 v22, v245, v86, v22
  v_dot2_f32_bf16 v24, v246, v86, v24
  v_dot2_f32_bf16 v26, v247, v86, v26
  v_dot2_f32_bf16 v21, v244, v28, v21
  v_dot2_f32_bf16 v23, v245, v28, v23
  v_dot2_f32_bf16 v25, v246, v28, v25
  v_dot2_f32_bf16 v27, v247, v28, v27
  v_lshlrev_b32 v28, 16, v87
  v_dot2_f32_bf16 v20, v248, v87, v20
  v_dot2_f32_bf16 v22, v249, v87, v22
  v_dot2_f32_bf16 v24, v250, v87, v24
  v_dot2_f32_bf16 v26, v251, v87, v26
  v_dot2_f32_bf16 v21, v248, v28, v21
  v_dot2_f32_bf16 v23, v249, v28, v23
  v_dot2_f32_bf16 v25, v250, v28, v25
  v_dot2_f32_bf16 v27, v251, v28, v27
  s_nop 2
  ds_write_b128 v90, v[20:23]
  ds_write_b128 v90, v[24:27] offset:16
  s_waitcnt vmcnt(0)
  s_mov_b32 s57, 0
L_tag_21:
  v_readfirstlane_b32 s56, v17
  s_cmp_eq_u32 s56, 0
  s_cbranch_scc1 L_taga_23
  s_sub_u32 s91, s56, s90
  s_cmp_gt_i32 s91, -1000
  s_cbranch_scc1 L_tagd_22
  s_cmp_gt_u32 s57, 64
  s_cbranch_scc1 L_tagd_22
L_taga_23:
  s_add_u32 s57, s57, 1
  s_cmp_gt_u32 s57, 400000
  s_cbranch_scc1 L_end
  global_load_dword v17, v18, s[36:37] sc1
  s_waitcnt vmcnt(0)
  s_branch L_tag_21
L_tagd_22:
  v_mov_b32 v17, s56
  s_branch L_s_bh
L_s_ctl:
  s_and_b32 s60, s4, 3
  s_lshl_b32 s60, s60, 9
  s_lshr_b32 s57, s4, 2
  s_lshl_b32 s57, s57, 8
  s_add_u32 s60, s60, s57
  s_and_b32 s57, s6, 7
  s_lshl_b32 s57, s57, 5
  s_add_u32 s60, s60, s57
  s_lshl_b32 s57, s3, 4
  s_add_u32 s7, s60, s57
  s_mul_i32 s60, s7, 1152
  v_lshlrev_b32 v2, 4, v1
  v_lshrrev_b32 v3, 3, v1
  v_lshrrev_b32 v4, 4, v1
  v_and_b32 v5, 7, v1
  v_xor_b32 v4, v4, v5
  v_mul_u32_u24 v3, 1152, v3
  v_lshl_add_u32 v3, v4, 4, v3
  v_add_u32 v3, 1024, v3
  v_xor_b32 v4, 64, v3
  s_mul_i32 m0, s3, 18432
  s_mov_b32 s10, 2359296
  s_mov_b32 s11, 0x20000
  s_mov_b32 s14, 1990656
  s_mov_b32 s15, 0x20000
  s_waitcnt lgkmcnt(0)
  v_xor_b32 v64, 0, v2
  buffer_load_dwordx4 v64, s[8:11], s60 offen lds
  v_xor_b32 v65, 16, v2
  s_add_u32 m0, m0, 1024
  s_add_u32 s60, s60, 1152
  buffer_load_dwordx4 v65, s[8:11], s60 offen lds
  v_xor_b32 v66, 32, v2
  s_add_u32 m0, m0, 1024
  s_add_u32 s60, s60, 1152
  buffer_load_dwordx4 v66, s[8:11], s60 offen lds
  v_xor_b32 v67, 48, v2
  s_add_u32 m0, m0, 1024
  s_add_u32 s60, s60, 1152
  buffer_load_dwordx4 v67, s[8:11], s60 offen lds
  v_xor_b32 v68, 64, v2
  s_add_u32 m0, m0, 1024
  s_add_u32 s60, s60, 1152
  buffer_load_dwordx4 v68, s[8:11], s60 offen lds
  v_xor_b32 v69, 80, v2
  s_add_u32 m0, m0, 1024
  s_add_u32 s60, s60, 1152
  buffer_load_dwordx4 v69, s[8:11], s60 offen lds
  v_xor_b32 v70, 96, v2
  s_add_u32 m0, m0, 1024
  s_add_u32 s60, s60, 1152
  buffer_load_dwordx4 v70, s[8:11], s60 offen lds
  v_xor_b32 v71, 112, v2
  s_add_u32 m0, m0, 1024
  s_add_u32 s60, s60, 1152
  buffer_load_dwordx4 v71, s[8:11], s60 offen lds
  v_xor_b32 v72, 128, v2
  s_add_u32 m0, m0, 1024
  s_add_u32 s60, s60, 1152
  buffer_load_dwordx4 v72, s[8:11], s60 offen lds
  v_xor_b32 v73, 144, v2
  s_add_u32 m0, m0, 1024
  s_add_u32 s60, s60, 1152
  buffer_load_dwordx4 v73, s[8:11], s60 offen lds
  v_xor_b32 v74, 160, v2
  s_add_u32 m0, m0, 1024
  s_add_u32 s60, s60, 1152
  buffer_load_dwordx4 v74, s[8:11], s60 offen lds
  v_xor_b32 v75, 176, v2
  s_add_u32 m0, m0, 1024
  s_add_u32 s60, s60, 1152
  buffer_load_dwordx4 v75, s[8:11], s60 offen lds
  v_xor_b32 v76, 192, v2
  s_add_u32 m0, m0, 1024
  s_add_u32 s60, s60, 1152
  buffer_load_dwordx4 v76, s[8:11], s60 offen lds
  v_xor_b32 v77, 208, v2
  s_add_u32 m0, m0, 1024
  s_add_u32 s60, s60, 1152
  buffer_load_dwordx4 v77, s[8:11], s60 offen lds
  v_xor_b32 v78, 224, v2
  s_add_u32 m0, m0, 1024
  s_add_u32 s60, s60, 1152
  buffer_load_dwordx4 v78, s[8:11], s60 offen lds
  v_xor_b32 v79, 240, v2
  s_add_u32 m0, m0, 1024
  s_add_u32 s60, s60, 1152
  buffer_load_dwordx4 v79, s[8:11], s60 offen lds
  s_add_u32 m0, m0, 1024
  s_sub_u32 s60, s60, 17280
  buffer_load_dwordx4 v3, s[8:11], s60 offen lds
  s_add_u32 m0, m0, 1024
  s_add_u32 s60, s60, 9216
  buffer_load_dwordx4 v4, s[8:11], s60 offen lds
  v_lshlrev_b32 v3, 4, v1
  s_mov_b32 s12, s24
  s_mov_b32 s13, s25
  s_mov_b32 s14, 1152
  s_mov_b32 s15, 0x20000
  s_mov_b32 m0, 36864
  s_nop 0
  buffer_load_dwordx4 v3, s[12:15], 0 offen lds
  buffer_load_dwordx4 v3, s[12:15], 0 offen offset:1024 lds
  s_mov_b32 s12, s32
  s_mov_b32 s13, s33
  s_mov_b32 s14, 1152
  s_mov_b32 s15, 0x20000
  s_mov_b32 m0, 38912
  s_nop 0
  buffer_load_dwordx4 v3, s[12:15], 0 offen lds
  buffer_load_dwordx4 v3, s[12:15], 0 offen offset:1024 lds
  s_barrier
  s_mov_b32 s40, s38
  s_mov_b32 s41, s39
  s_mov_b32 s42, 14680064
  s_mov_b32 s43, 0x20000
  s_mov_b32 s44, s34
  s_mov_b32 s45, s35
  s_mov_b32 s46, 2359296
  s_mov_b32 s47, 0x20000
  v_mov_b32 v18, 0
  global_load_dword v17, v18, s[36:37] sc1
  v_and_b32 v10, 15, v1
  v_lshrrev_b32 v11, 4, v1
  v_and_b32 v2, 1, v10
  v_lshlrev_b32 v2, 11, v2
  v_lshl_add_u32 v2, v11, 4, v2
  v_add_u32 v2, 36864, v2
  s_mul_i32 s57, s3, 18432
  v_lshl_add_u32 v3, v10, 10, s57
  v_xor_b32 v4, v10, v11
  v_xor_b32 v5, 0, v4
  v_lshl_add_u32 v40, v5, 4, v3
  v_xor_b32 v5, 4, v4
  v_lshl_add_u32 v41, v5, 4, v3
  v_xor_b32 v5, 8, v4
  v_lshl_add_u32 v42, v5, 4, v3
  v_xor_b32 v5, 12, v4
  v_lshl_add_u32 v43, v5, 4, v3
  s_add_u32 s57, s57, 16384
  v_lshl_add_u32 v3, v10, 7, s57
  v_lshrrev_b32 v4, 1, v10
  v_xor_b32 v4, v4, v11
  v_xor_b32 v5, 4, v4
  v_lshl_add_u32 v44, v4, 4, v3
  v_lshl_add_u32 v45, v5, 4, v3
  s_waitcnt vmcnt(0)
  s_mov_b32 s57, 0
L_tag_24:
  v_readfirstlane_b32 s56, v17
  s_cmp_eq_u32 s56, 0
  s_cbranch_scc1 L_taga_26
  s_sub_u32 s91, s56, s90
  s_cmp_gt_i32 s91, -1000
  s_cbranch_scc1 L_tagd_25
  s_cmp_gt_u32 s57, 64
  s_cbranch_scc1 L_tagd_25
L_taga_26:
  s_add_u32 s57, s57, 1
  s_cmp_gt_u32 s57, 400000
  s_cbranch_scc1 L_end
  global_load_dword v17, v18, s[36:37] sc1
  s_waitcnt vmcnt(0)
  s_branch L_tag_24
L_tagd_25:
  v_mov_b32 v17, s56
  ds_read_b128 v[64:67], v2 offset:0
  ds_read_b128 v[68:71], v40 offset:0
  ds_read_b128 v[72:75], v2 offset:64
  ds_read_b128 v[76:79], v41 offset:0
  ds_read_b128 v[80:83], v2 offset:128
  ds_read_b128 v[84:87], v42 offset:0
  ds_read_b128 v[88:91], v2 offset:192
  ds_read_b128 v[92:95], v43 offset:0
  ds_read_b128 v[96:99], v2 offset:256
  ds_read_b128 v[100:103], v40 offset:256
  ds_read_b128 v[104:107], v2 offset:320
  ds_read_b128 v[108:111], v41 offset:256
  s_waitcnt lgkmcnt(0)
  v_mfma_f32_16x16x32_bf16 v[20:23], v[64:67], v[68:71], 0
  v_mfma_f32_16x16x32_bf16 v[20:23], v[72:75], v[76:79], v[20:23]
  v_mfma_f32_16x16x32_bf16 v[20:23], v[80:83], v[84:87], v[20:23]
  v_mfma_f32_16x16x32_bf16 v[20:23], v[88:91], v[92:95], v[20:23]
  v_mfma_f32_16x16x32_bf16 v[20:23], v[96:99], v[100:103], v[20:23]
  v_mfma_f32_16x16x32_bf16 v[20:23], v[104:107], v[108:111], v[20:23]
  ds_read_b128 v[112:115], v2 offset:384
  ds_read_b128 v[116:119], v42 offset:256
  ds_read_b128 v[120:123], v2 offset:448
  ds_read_b128 v[124:127], v43 offset:256
  ds_read_b128 v[128:131], v2 offset:512
  ds_read_b128 v[132:135], v40 offset:512
  ds_read_b128 v[136:139], v2 offset:576
  ds_read_b128 v[140:143], v41 offset:512
  ds_read_b128 v[144:147], v2 offset:640
  ds_read_b128 v[148:151], v42 offset:512
  ds_read_b128 v[152:155], v2 offset:704
  ds_read_b128 v[156:159], v43 offset:512
  s_waitcnt lgkmcnt(0)
  v_mfma_f32_16x16x32_bf16 v[20:23], v[112:115], v[116:119], v[20:23]
  v_mfma_f32_16x16x32_bf16 v[20:23], v[120:123], v[124:127], v[20:23]
  v_mfma_f32_16x16x32_bf16 v[20:23], v[128:131], v[132:135], v[20:23]
  v_mfma_f32_16x16x32_bf16 v[20:23], v[136:139], v[140:143], v[20:23]
  v_mfma_f32_16x16x32_bf16 v[20:23], v[144:147], v[148:151], v[20:23]
  v_mfma_f32_16x16x32_bf16 v[20:23], v[152:155], v[156:159], v[20:23]
  ds_read_b128 v[160:163], v2 offset:768
  ds_read_b128 v[164:167], v40 offset:768
  ds_read_b128 v[168:171], v2 offset:832
  ds_read_b128 v[172:175], v41 offset:768
  ds_read_b128 v[176:179], v2 offset:896
  ds_read_b128 v[180:183], v42 offset:768
  ds_read_b128 v[184:187], v2 offset:960
  ds_read_b128 v[188:191], v43 offset:768
  ds_read_b128 v[192:195], v2 offset:1024
  ds_read_b128 v[196:199], v44
  ds_read_b128 v[200:203], v2 offset:1088
  ds_read_b128 v[204:207], v45
  s_waitcnt lgkmcnt(0)
  v_mfma_f32_16x16x32_bf16 v[20:23], v[160:163], v[164:167], v[20:23]
  v_mfma_f32_16x16x32_bf16 v[20:23], v[168:171], v[172:175], v[20:23]
  v_mfma_f32_16x16x32_bf16 v[20:23], v[176:179], v[180:183], v[20:23]
  v_mfma_f32_16x16x32_bf16 v[20:23], v[184:187], v[188:191], v[20:23]
  v_mfma_f32_16x16x32_bf16 v[20:23], v[192:195], v[196:199], v[20:23]
  v_mfma_f32_16x16x32_bf16 v[20:23], v[200:203], v[204:207], v[20:23]
  s_mov_b32 s57, s7
  v_add_u32 v24, s57, v10
  s_nop 6
  v_cvt_pk_bf16_f32 v20, v20, v20
  v_lshrrev_b32 v20, 16, v20
  v_bfe_i32 v22, v20, 15, 1
  v_and_b32 v22, 0x7fff, v22
  v_xor_b32 v20, 0x8000, v20
  v_xor_b32 v20, v20, v22
  v_sub_u32 v22, 2047, v24
  v_lshl_add_u32 v20, v20, 16, v22
  v_cvt_pk_bf16_f32 v21, v21, v21
  v_and_b32 v21, 0xffff0000, v21
  v_mul_f32 v26, 0xbfb8aa3b, v21
  v_exp_f32 v26, v26
  s_nop 0
  v_add_f32 v26, 1.0, v26
  v_rcp_f32 v26, v26
  s_nop 0
  v_cvt_pk_bf16_f32 v26, v26, v26
  v_and_b32 v26, 0xffff0000, v26
  v_mov_b32 v27, v17
  v_lshlrev_b32 v24, 3, v24
  s_nop 1
  v_max_u32_dpp v20, v20, v20 row_ror:8 row_mask:0xf bank_mask:0xf
  s_nop 1
  v_max_u32_dpp v20, v20, v20 row_ror:4 row_mask:0xf bank_mask:0xf
  s_nop 1
  v_max_u32_dpp v20, v20, v20 row_ror:2 row_mask:0xf bank_mask:0xf
  s_nop 1
  v_max_u32_dpp v20, v20, v20 row_ror:1 row_mask:0xf bank_mask:0xf
  v_mov_b32 v21, v17
  s_lshr_b32 s57, s57, 1
  s_add_u32 s57, s57, 65536
  s_mov_b32 s58, 81920
  s_mov_b64 exec, 1
  buffer_store_dwordx2 v[20:21], v18, s[40:43], s57 offen sc1
  s_mov_b64 exec, 0xffff
  buffer_store_dwordx2 v[26:27], v24, s[40:43], s58 offen sc1
  s_mov_b64 exec, -1
  s_cmp_eq_u32 s3, 0
  s_cbranch_scc0 L_s_nocand
  s_sleep 24
  v_lshlrev_b32 v24, 4, v1
  s_mov_b32 s57, 65536
  buffer_load_dwordx4 v[20:23], v24, s[40:43], s57 offen sc1
  s_waitcnt vmcnt(0)
  s_mov_b32 s58, 0
L_cand_27:
  v_xor_b32 v21, v17, v21
  v_xor_b32 v23, v17, v23
  v_or_b32 v21, v21, v23
  v_cmp_eq_u32 vcc, 0, v21
  s_cmp_eq_u64 vcc, -1
  s_cbranch_scc1 L_candd_28
  s_add_u32 s58, s58, 1
  s_cmp_gt_u32 s58, 400000
  s_cbranch_scc1 L_end
  s_sleep 8
  s_mov_b32 s57, 65536
  buffer_load_dwordx4 v[20:23], v24, s[40:43], s57 offen sc1
  s_waitcnt vmcnt(0)
  s_branch L_cand_27
L_candd_28:
  v_max_u32 v20, v20, v22
  s_nop 1
  v_max_u32_dpp v20, v20, v20 row_ror:8 row_mask:0xf bank_mask:0xf
  s_nop 1
  v_max_u32_dpp v20, v20, v20 row_ror:4 row_mask:0xf bank_mask:0xf
  s_nop 1
  v_max_u32_dpp v20, v20, v20 row_ror:2 row_mask:0xf bank_mask:0xf
  s_nop 1
  v_max_u32_dpp v20, v20, v20 row_ror:1 row_mask:0xf bank_mask:0xf
  v_mov_b32 v21, v20
  s_nop 1
  v_permlane16_swap_b32 v20, v21
  v_max_u32 v20, v20, v21
  v_mov_b32 v21, v20
  s_nop 1
  v_permlane32_swap_b32 v20, v21
  v_max_u32 v20, v20, v21
  s_nop 0
  v_readfirstlane_b32 s84, v20
  s_and_b32 s83, s84, 0xffff
  s_sub_u32 s83, 2047, s83
  s_mul_i32 s57, s83, 1152
  s_mov_b32 m0, 40960
  s_nop 0
  buffer_load_dwordx4 v24, s[8:11], s57 offen lds
  buffer_load_dwordx4 v24, s[8:11], s57 offen offset:1024 lds
  s_waitcnt vmcnt(0)
  s_barrier
  s_mov_b32 s86, 3
  s_branch L_p2
L_prepret3:
  s_branch L_s_bh
L_s_nocand:
  s_mov_b32 s48, s26
  s_mov_b32 s49, s27
  s_mov_b32 s50, 5308416
  s_mov_b32 s51, 0x20000
  s_mov_b32 s52, s28
  s_mov_b32 s53, s29
  s_mov_b32 s54, 5308416
  s_mov_b32 s55, 0x20000
  s_and_b32 s57, s6, 7
  s_mul_i32 s58, s57, 144
  v_add_u32 v89, s58, v7
  s_mul_i32 s57, s57, 663552
  s_lshr_b32 s58, s6, 3
  s_lshl_b32 s58, s58, 7
  s_add_u32 s57, s57, s58
  s_add_u32 s57, s57, 8192
  buffer_load_dwordx4 v[156:159], v6, s[48:51], s57 offen nt
  buffer_load_dwordx4 v[192:195], v6, s[52:55], s57 offen nt
  s_add_u32 s57, s57, 73728
  buffer_load_dwordx4 v[160:163], v6, s[48:51], s57 offen nt
  buffer_load_dwordx4 v[196:199], v6, s[52:55], s57 offen nt
  s_add_u32 s57, s57, 73728
  buffer_load_dwordx4 v[164:167], v6, s[48:51], s57 offen nt
  buffer_load_dwordx4 v[200:203], v6, s[52:55], s57 offen nt
  s_add_u32 s57, s57, 73728
  buffer_load_dwordx4 v[168:171], v6, s[48:51], s57 offen nt
  buffer_load_dwordx4 v[204:207], v6, s[52:55], s57 offen nt
  s_add_u32 s57, s57, 73728
  buffer_load_dwordx4 v[172:175], v6, s[48:51], s57 offen nt
  buffer_load_dwordx4 v[208:211], v6, s[52:55], s57 offen nt
  s_add_u32 s57, s57, 73728
  buffer_load_dwordx4 v[176:179], v6, s[48:51], s57 offen nt
  buffer_load_dwordx4 v[212:215], v6, s[52:55], s57 offen nt
  s_add_u32 s57, s57, 73728
  buffer_load_dwordx4 v[180:183], v6, s[48:51], s57 offen nt
  buffer_load_dwordx4 v[216:219], v6, s[52:55], s57 offen nt
  s_add_u32 s57, s57, 73728
  buffer_load_dwordx4 v[184:187], v6, s[48:51], s57 offen nt
  buffer_load_dwordx4 v[220:223], v6, s[52:55], s57 offen nt
  s_add_u32 s57, s57, 73728
  buffer_load_dwordx4 v[188:191], v6, s[48:51], s57 offen nt
  buffer_load_dwordx4 v[224:227], v6, s[52:55], s57 offen nt
  s_mov_b32 s86, 2
  s_branch L_p2
L_prepret2:
  v_and_b32 v90, 7, v1
  v_lshrrev_b32 v88, 4, v1
  v_lshlrev_b32 v88, 1, v88
  v_lshl_add_u32 v90, v90, 3, v88
  v_lshlrev_b32 v90, 3, v90
  s_mul_i32 s59, s6, 9216
  s_add_u32 s59, s59, 397312
  s_add_u32 s60, s59, 4608
  s_barrier
  s_waitcnt vmcnt(0)
  ds_read_u16 v64, v89 offset:0
  ds_read_u16 v65, v89 offset:16
  ds_read_u16 v66, v89 offset:32
  ds_read_u16 v67, v89 offset:48
  ds_read_u16 v68, v89 offset:64
  ds_read_u16 v69, v89 offset:80
  ds_read_u16 v70, v89 offset:96
  ds_read_u16 v71, v89 offset:112
  ds_read_u16 v72, v89 offset:128
  v_mov_b32 v20, 0
  v_mov_b32 v21, 0
  v_mov_b32 v22, 0
  v_mov_b32 v23, 0
  v_mov_b32 v24, 0
  v_mov_b32 v25, 0
  v_mov_b32 v26, 0
  v_mov_b32 v27, 0
  s_waitcnt lgkmcnt(0)
  v_lshlrev_b32 v28, 16, v64
  v_dot2_f32_bf16 v20, v156, v64, v20
  v_dot2_f32_bf16 v22, v157, v64, v22
  v_dot2_f32_bf16 v24, v158, v64, v24
  v_dot2_f32_bf16 v26, v159, v64, v26
  v_dot2_f32_bf16 v21, v156, v28, v21
  v_dot2_f32_bf16 v23, v157, v28, v23
  v_dot2_f32_bf16 v25, v158, v28, v25
  v_dot2_f32_bf16 v27, v159, v28, v27
  v_lshlrev_b32 v28, 16, v65
  v_dot2_f32_bf16 v20, v160, v65, v20
  v_dot2_f32_bf16 v22, v161, v65, v22
  v_dot2_f32_bf16 v24, v162, v65, v24
  v_dot2_f32_bf16 v26, v163, v65, v26
  v_dot2_f32_bf16 v21, v160, v28, v21
  v_dot2_f32_bf16 v23, v161, v28, v23
  v_dot2_f32_bf16 v25, v162, v28, v25
  v_dot2_f32_bf16 v27, v163, v28, v27
  v_lshlrev_b32 v28, 16, v66
  v_dot2_f32_bf16 v20, v164, v66, v20
  v_dot2_f32_bf16 v22, v165, v66, v22
  v_dot2_f32_bf16 v24, v166, v66, v24
  v_dot2_f32_bf16 v26, v167, v66, v26
  v_dot2_f32_bf16 v21, v164, v28, v21
  v_dot2_f32_bf16 v23, v165, v28, v23
  v_dot2_f32_bf16 v25, v166, v28, v25
  v_dot2_f32_bf16 v27, v167, v28, v27
  v_lshlrev_b32 v28, 16, v67
  v_dot2_f32_bf16 v20, v168, v67, v20
  v_dot2_f32_bf16 v22, v169, v67, v22
  v_dot2_f32_bf16 v24, v170, v67, v24
  v_dot2_f32_bf16 v26, v171, v67, v26
  v_dot2_f32_bf16 v21, v168, v28, v21
  v_dot2_f32_bf16 v23, v169, v28, v23
  v_dot2_f32_bf16 v25, v170, v28, v25
  v_dot2_f32_bf16 v27, v171, v28, v27
  v_lshlrev_b32 v28, 16, v68
  v_dot2_f32_bf16 v20, v172, v68, v20
  v_dot2_f32_bf16 v22, v173, v68, v22
  v_dot2_f32_bf16 v24, v174, v68, v24
  v_dot2_f32_bf16 v26, v175, v68, v26
  v_dot2_f32_bf16 v21, v172, v28, v21
  v_dot2_f32_bf16 v23, v173, v28, v23
  v_dot2_f32_bf16 v25, v174, v28, v25
  v_dot2_f32_bf16 v27, v175, v28, v27
  v_lshlrev_b32 v28, 16, v69
  v_dot2_f32_bf16 v20, v176, v69, v20
  v_dot2_f32_bf16 v22, v177, v69, v22
  v_dot2_f32_bf16 v24, v178, v69, v24
  v_dot2_f32_bf16 v26, v179, v69, v26
  v_dot2_f32_bf16 v21, v176, v28, v21
  v_dot2_f32_bf16 v23, v177, v28, v23
  v_dot2_f32_bf16 v25, v178, v28, v25
  v_dot2_f32_bf16 v27, v179, v28, v27
  v_lshlrev_b32 v28, 16, v70
  v_dot2_f32_bf16 v20, v180, v70, v20
  v_dot2_f32_bf16 v22, v181, v70, v22
  v_dot2_f32_bf16 v24, v182, v70, v24
  v_dot2_f32_bf16 v26, v183, v70, v26
  v_dot2_f32_bf16 v21, v180, v28, v21
  v_dot2_f32_bf16 v23, v181, v28, v23
  v_dot2_f32_bf16 v25, v182, v28, v25
  v_dot2_f32_bf16 v27, v183, v28, v27
  v_lshlrev_b32 v28, 16, v71
  v_dot2_f32_bf16 v20, v184, v71, v20
  v_dot2_f32_bf16 v22, v185, v71, v22
  v_dot2_f32_bf16 v24, v186, v71, v24
  v_dot2_f32_bf16 v26, v187, v71, v26
  v_dot2_f32_bf16 v21, v184, v28, v21
  v_dot2_f32_bf16 v23, v185, v28, v23
  v_dot2_f32_bf16 v25, v186, v28, v25
  v_dot2_f32_bf16 v27, v187, v28, v27
  v_lshlrev_b32 v28, 16, v72
  v_dot2_f32_bf16 v20, v188, v72, v20
  v_dot2_f32_bf16 v22, v189, v72, v22
  v_dot2_f32_bf16 v24, v190, v72, v24
  v_dot2_f32_bf16 v26, v191, v72, v26
  v_dot2_f32_bf16 v21, v188, v28, v21
  v_dot2_f32_bf16 v23, v189, v28, v23
  v_dot2_f32_bf16 v25, v190, v28, v25
  v_dot2_f32_bf16 v27, v191, v28, v27
  s_nop 2
  v_permlane32_swap_b32 v20, v24
  v_permlane32_swap_b32 v21, v25
  v_permlane32_swap_b32 v22, v26
  v_permlane32_swap_b32 v23, v27
  v_add_f32 v20, v20, v24
  v_add_f32 v21, v21, v25
  v_add_f32 v22, v22, v26
  v_add_f32 v23, v23, v27
  s_nop 0
  v_permlane16_swap_b32 v20, v22
  v_permlane16_swap_b32 v21, v23
  v_add_f32 v20, v20, v22
  v_add_f32 v21, v21, v23
  s_nop 0
  v_add_f32_dpp v20, v20, v20 row_ror:8 row_mask:0xf bank_mask:0xf
  v_add_f32_dpp v21, v21, v21 row_ror:8 row_mask:0xf bank_mask:0xf
  v_mov_b32 v22, v21
  v_mov_b32 v21, v17
  v_mov_b32 v23, v17
  buffer_store_dwordx4 v[20:23], v90, s[40:43], s59 offen sc1
  s_nop 1
  v_mov_b32 v20, 0
  v_mov_b32 v21, 0
  v_mov_b32 v22, 0
  v_mov_b32 v23, 0
  v_mov_b32 v24, 0
  v_mov_b32 v25, 0
  v_mov_b32 v26, 0
  v_mov_b32 v27, 0
  s_waitcnt lgkmcnt(0)
  v_lshlrev_b32 v28, 16, v64
  v_dot2_f32_bf16 v20, v192, v64, v20
  v_dot2_f32_bf16 v22, v193, v64, v22
  v_dot2_f32_bf16 v24, v194, v64, v24
  v_dot2_f32_bf16 v26, v195, v64, v26
  v_dot2_f32_bf16 v21, v192, v28, v21
  v_dot2_f32_bf16 v23, v193, v28, v23
  v_dot2_f32_bf16 v25, v194, v28, v25
  v_dot2_f32_bf16 v27, v195, v28, v27
  v_lshlrev_b32 v28, 16, v65
  v_dot2_f32_bf16 v20, v196, v65, v20
  v_dot2_f32_bf16 v22, v197, v65, v22
  v_dot2_f32_bf16 v24, v198, v65, v24
  v_dot2_f32_bf16 v26, v199, v65, v26
  v_dot2_f32_bf16 v21, v196, v28, v21
  v_dot2_f32_bf16 v23, v197, v28, v23
  v_dot2_f32_bf16 v25, v198, v28, v25
  v_dot2_f32_bf16 v27, v199, v28, v27
  v_lshlrev_b32 v28, 16, v66
  v_dot2_f32_bf16 v20, v200, v66, v20
  v_dot2_f32_bf16 v22, v201, v66, v22
  v_dot2_f32_bf16 v24, v202, v66, v24
  v_dot2_f32_bf16 v26, v203, v66, v26
  v_dot2_f32_bf16 v21, v200, v28, v21
  v_dot2_f32_bf16 v23, v201, v28, v23
  v_dot2_f32_bf16 v25, v202, v28, v25
  v_dot2_f32_bf16 v27, v203, v28, v27
  v_lshlrev_b32 v28, 16, v67
  v_dot2_f32_bf16 v20, v204, v67, v20
  v_dot2_f32_bf16 v22, v205, v67, v22
  v_dot2_f32_bf16 v24, v206, v67, v24
  v_dot2_f32_bf16 v26, v207, v67, v26
  v_dot2_f32_bf16 v21, v204, v28, v21
  v_dot2_f32_bf16 v23, v205, v28, v23
  v_dot2_f32_bf16 v25, v206, v28, v25
  v_dot2_f32_bf16 v27, v207, v28, v27
  v_lshlrev_b32 v28, 16, v68
  v_dot2_f32_bf16 v20, v208, v68, v20
  v_dot2_f32_bf16 v22, v209, v68, v22
  v_dot2_f32_bf16 v24, v210, v68, v24
  v_dot2_f32_bf16 v26, v211, v68, v26
  v_dot2_f32_bf16 v21, v208, v28, v21
  v_dot2_f32_bf16 v23, v209, v28, v23
  v_dot2_f32_bf16 v25, v210, v28, v25
  v_dot2_f32_bf16 v27, v211, v28, v27
  v_lshlrev_b32 v28, 16, v69
  v_dot2_f32_bf16 v20, v212, v69, v20
  v_dot2_f32_bf16 v22, v213, v69, v22
  v_dot2_f32_bf16 v24, v214, v69, v24
  v_dot2_f32_bf16 v26, v215, v69, v26
  v_dot2_f32_bf16 v21, v212, v28, v21
  v_dot2_f32_bf16 v23, v213, v28, v23
  v_dot2_f32_bf16 v25, v214, v28, v25
  v_dot2_f32_bf16 v27, v215, v28, v27
  v_lshlrev_b32 v28, 16, v70
  v_dot2_f32_bf16 v20, v216, v70, v20
  v_dot2_f32_bf16 v22, v217, v70, v22
  v_dot2_f32_bf16 v24, v218, v70, v24
  v_dot2_f32_bf16 v26, v219, v70, v26
  v_dot2_f32_bf16 v21, v216, v28, v21
  v_dot2_f32_bf16 v23, v217, v28, v23
  v_dot2_f32_bf16 v25, v218, v28, v25
  v_dot2_f32_bf16 v27, v219, v28, v27
  v_lshlrev_b32 v28, 16, v71
  v_dot2_f32_bf16 v20, v220, v71, v20
  v_dot2_f32_bf16 v22, v221, v71, v22
  v_dot2_f32_bf16 v24, v222, v71, v24
  v_dot2_f32_bf16 v26, v223, v71, v26
  v_dot2_f32_bf16 v21, v220, v28, v21
  v_dot2_f32_bf16 v23, v221, v28, v23
  v_dot2_f32_bf16 v25, v222, v28, v25
  v_dot2_f32_bf16 v27, v223, v28, v27
  v_lshlrev_b32 v28, 16, v72
  v_dot2_f32_bf16 v20, v224, v72, v20
  v_dot2_f32_bf16 v22, v225, v72, v22
  v_dot2_f32_bf16 v24, v226, v72, v24
  v_dot2_f32_bf16 v26, v227, v72, v26
  v_dot2_f32_bf16 v21, v224, v28, v21
  v_dot2_f32_bf16 v23, v225, v28, v23
  v_dot2_f32_bf16 v25, v226, v28, v25
  v_dot2_f32_bf16 v27, v227, v28, v27
  s_nop 2
  v_permlane32_swap_b32 v20, v24
  v_permlane32_swap_b32 v21, v25
  v_permlane32_swap_b32 v22, v26
  v_permlane32_swap_b32 v23, v27
  v_add_f32 v20, v20, v24
  v_add_f32 v21, v21, v25
  v_add_f32 v22, v22, v26
  v_add_f32 v23, v23, v27
  s_nop 0
  v_permlane16_swap_b32 v20, v22
  v_permlane16_swap_b32 v21, v23
  v_add_f32 v20, v20, v22
  v_add_f32 v21, v21, v23
  s_nop 0
  v_add_f32_dpp v20, v20, v20 row_ror:8 row_mask:0xf bank_mask:0xf
  v_add_f32_dpp v21, v21, v21 row_ror:8 row_mask:0xf bank_mask:0xf
  v_mov_b32 v22, v21
  v_mov_b32 v21, v17
  v_mov_b32 v23, v17
  buffer_store_dwordx4 v[20:23], v90, s[40:43], s60 offen sc1
  s_nop 1
L_s_bh:
  s_waitcnt lgkmcnt(0)
  s_barrier
  s_lshr_b32 s57, s3, 2
  s_and_b32 s58, s3, 3
  s_mul_i32 s59, s57, 6144
  s_lshl_b32 s60, s58, 9
  s_add_u32 s59, s59, s60
  s_add_u32 s59, s59, 43008
  v_lshl_add_u32 v90, v1, 3, s59
  ds_read_b64 v[20:21], v90 offset:0
  ds_read_b64 v[22:23], v90 offset:2048
  ds_read_b64 v[24:25], v90 offset:4096
  s_mul_i32 s57, s57, 4608
  s_lshl_b32 s58, s58, 10
  s_add_u32 s57, s57, s58
  s_mul_i32 s58, s6, 9216
  s_add_u32 s57, s57, s58
  s_add_u32 s57, s57, 393216
  s_waitcnt lgkmcnt(0)
  v_add_f32 v20, v20, v22
  v_add_f32 v22, v21, v23
  v_add_f32 v20, v20, v24
  v_add_f32 v22, v22, v25
  v_mov_b32 v21, v17
  v_mov_b32 v23, v17
  buffer_store_dwordx4 v[20:23], v3, s[40:43], s57 offen sc1
  s_barrier
  s_branch L_p2b
L_p2:
  s_and_b32 s57, s5, 3
  s_lshl_b32 s76, s4, 2
  s_add_u32 s76, s76, s57
  s_lshr_b32 s80, s5, 2
  s_add_u32 s77, s80, 1
  s_and_b32 s77, s77, 7
  s_sub_u32 s78, 11, s3
  s_cmp_lt_u32 s3, 4
  s_cselect_b32 s78, s3, s78
  s_lshl_b32 s79, s57, 6
  s_and_b32 s57, s4, 3
  s_lshl_b32 s57, s57, 9
  s_add_u32 s79, s79, s57
  s_lshr_b32 s57, s4, 2
  s_lshl_b32 s57, s57, 8
  s_add_u32 s79, s79, s57
  s_sub_u32 s82, 8, s78
  s_cmp_eq_u32 s77, 0
  s_cselect_b32 s82, s82, 0
  s_lshl_b32 s63, s77, 12
  s_lshl_b32 s64, s78, 9
  s_add_u32 s67, s63, s64
  s_lshl_b32 s64, s76, 16
  s_add_u32 s68, s63, s64
  s_add_u32 s68, s68, 3141632
  s_lshr_b32 s93, s76, 1
  s_lshl_b32 s93, s93, 15
  s_add_u32 s69, s63, s93
  s_add_u32 s69, s69, 7860224
  v_and_b32 v10, 31, v1
  v_lshrrev_b32 v11, 5, v1
  v_lshlrev_b32 v3, 4, v1
  v_lshlrev_b32 v2, 15, v11
  v_lshl_add_u32 v2, v10, 4, v2
  v_lshlrev_b32 v4, 13, v11
  v_lshl_add_u32 v4, v10, 4, v4
  s_lshl_b32 s57, s78, 9
  v_add_u32 v4, s57, v4
  s_and_b32 s92, s76, 1
  s_lshl_b32 s92, s92, 3
  s_add_u32 s60, s57, s92
  s_lshr_b32 s60, s60, 1
  s_add_u32 s61, s60, 16384
  v_lshl_add_u32 v5, v10, 3, s61
  v_subrev_u32 v7, 1, v11
  v_lshlrev_b32 v12, 30, v11
  v_lshl_add_u32 v8, v10, 3, v12
  v_lshl_add_u32 v9, v10, 2, v12
  v_bfe_u32 v12, v1, 2, 2
  v_lshl_add_u32 v12, v11, 2, v12
  v_lshlrev_b32 v12, 4, v12
  v_bfe_u32 v13, v1, 1, 1
  v_mul_u32_u24 v13, 8256, v13
  v_and_b32 v14, 1, v1
  v_lshl_add_u32 v13, v14, 3, v13
  v_add_u32 v13, 24576, v13
  s_add_u32 s61, s92, 41088
  v_sub_u32 v14, s61, v13
  v_bfe_u32 v15, v1, 4, 1
  v_mul_u32_u24 v14, v14, v15
  v_add_u32 v13, v13, v14
  v_add3_u32 v6, v12, v13, s57
  v_lshlrev_b32 v12, 2, v11
  v_sub_u32 v12, v10, v12
  s_mov_b32 s57, 4048155338
  v_subrev_u32 v13, 0, v12
  v_ashrrev_i32 v13, 31, v13
  v_and_b32 v112, s57, v13
  v_xor_b32 v128, s57, v112
  v_subrev_u32 v13, 1, v12
  v_ashrrev_i32 v13, 31, v13
  v_and_b32 v113, s57, v13
  v_xor_b32 v129, s57, v113
  v_subrev_u32 v13, 2, v12
  v_ashrrev_i32 v13, 31, v13
  v_and_b32 v114, s57, v13
  v_xor_b32 v130, s57, v114
  v_subrev_u32 v13, 3, v12
  v_ashrrev_i32 v13, 31, v13
  v_and_b32 v115, s57, v13
  v_xor_b32 v131, s57, v115
  v_subrev_u32 v13, 8, v12
  v_ashrrev_i32 v13, 31, v13
  v_and_b32 v116, s57, v13
  v_xor_b32 v132, s57, v116
  v_subrev_u32 v13, 9, v12
  v_ashrrev_i32 v13, 31, v13
  v_and_b32 v117, s57, v13
  v_xor_b32 v133, s57, v117
  v_subrev_u32 v13, 10, v12
  v_ashrrev_i32 v13, 31, v13
  v_and_b32 v118, s57, v13
  v_xor_b32 v134, s57, v118
  v_subrev_u32 v13, 11, v12
  v_ashrrev_i32 v13, 31, v13
  v_and_b32 v119, s57, v13
  v_xor_b32 v135, s57, v119
  v_subrev_u32 v13, 16, v12
  v_ashrrev_i32 v13, 31, v13
  v_and_b32 v120, s57, v13
  v_xor_b32 v136, s57, v120
  v_subrev_u32 v13, 17, v12
  v_ashrrev_i32 v13, 31, v13
  v_and_b32 v121, s57, v13
  v_xor_b32 v137, s57, v121
  v_subrev_u32 v13, 18, v12
  v_ashrrev_i32 v13, 31, v13
  v_and_b32 v122, s57, v13
  v_xor_b32 v138, s57, v122
  v_subrev_u32 v13, 19, v12
  v_ashrrev_i32 v13, 31, v13
  v_and_b32 v123, s57, v13
  v_xor_b32 v139, s57, v123
  v_subrev_u32 v13, 24, v12
  v_ashrrev_i32 v13, 31, v13
  v_and_b32 v124, s57, v13
  v_xor_b32 v140, s57, v124
  v_subrev_u32 v13, 25, v12
  v_ashrrev_i32 v13, 31, v13
  v_and_b32 v125, s57, v13
  v_xor_b32 v141, s57, v125
  v_subrev_u32 v13, 26, v12
  v_ashrrev_i32 v13, 31, v13
  v_and_b32 v126, s57, v13
  v_xor_b32 v142, s57, v126
  v_subrev_u32 v13, 27, v12
  v_ashrrev_i32 v13, 31, v13
  v_and_b32 v127, s57, v13
  v_xor_b32 v143, s57, v127
  s_lshl_b32 s57, s5, 3
  s_add_u32 s57, s57, s4
  s_mul_i32 s70, s57, 7282
  s_lshr_b32 s70, s70, 16
  s_mul_i32 s58, s70, 9
  s_sub_u32 s71, s57, s58
  s_mov_b32 s48, s30
  s_mov_b32 s49, s31
  s_mov_b32 s50, 5308416
  s_mov_b32 s51, 0x20000
  v_lshrrev_b32 v12, 3, v1
  s_mul_i32 s57, s70, 224
  s_mul_i32 s58, s3, 56
  s_add_u32 s57, s57, s58
  v_add_u32 v12, s57, v12
  v_add_u32 v55, s57, v1
  v_min_u32 v55, 4607, v55
  v_lshlrev_b32 v55, 3, v55
  v_mul_u32_u24 v54, 1152, v12
  v_and_b32 v12, 7, v1
  v_lshl_add_u32 v54, v12, 4, v54
  s_mul_i32 s57, s79, 1152
  s_mul_i32 s58, s80, 144
  s_add_u32 s57, s57, s58
  s_lshl_b32 s58, s79, 3
  s_add_u32 s58, s58, 81920
  v_lshrrev_b32 v12, 3, v0
  v_and_b32 v13, 7, v0
  v_mul_u32_u24 v150, 336, v12
  v_lshl_add_u32 v149, v13, 5, v150
  v_lshl_add_u32 v150, v13, 2, v150
  v_mul_u32_u24 v152, 1152, v12
  v_add_u32 v152, s57, v152
  v_lshl_add_u32 v151, v13, 4, v152
  v_lshl_add_u32 v152, v13, 1, v152
  v_lshl_add_u32 v153, v12, 3, s58
  s_mov_b32 s52, s20
  s_mov_b32 s53, s21
  s_mov_b32 s54, 663552
  s_mov_b32 s55, 0x20000
  s_mul_i32 s72, s80, 144
  s_add_u32 s57, s3, 8
  s_sub_u32 s58, s3, 4
  s_cmp_lt_u32 s3, 4
  s_cselect_b32 s57, s57, s58
  s_mul_i32 s58, s57, 36864
  s_add_u32 s72, s72, s58
  s_mul_i32 s73, s57, 5120
  s_add_u32 s73, s73, 49408
  v_mul_u32_u24 v11, 6554, v1
  v_lshrrev_b32 v11, 16, v11
  v_mul_u32_u24 v12, 10, v11
  v_sub_u32 v12, v1, v12
  v_mul_u32_u24 v11, 1152, v11
  v_lshl_add_u32 v144, v12, 4, v11
  v_add_u32 v10, 64, v1
  v_mul_u32_u24 v11, 6554, v10
  v_lshrrev_b32 v11, 16, v11
  v_mul_u32_u24 v12, 10, v11
  v_sub_u32 v12, v10, v12
  v_mul_u32_u24 v11, 1152, v11
  v_lshl_add_u32 v145, v12, 4, v11
  v_add_u32 v10, 128, v1
  v_mul_u32_u24 v11, 6554, v10
  v_lshrrev_b32 v11, 16, v11
  v_mul_u32_u24 v12, 10, v11
  v_sub_u32 v12, v10, v12
  v_mul_u32_u24 v11, 1152, v11
  v_lshl_add_u32 v146, v12, 4, v11
  v_add_u32 v10, 192, v1
  v_mul_u32_u24 v11, 6554, v10
  v_lshrrev_b32 v11, 16, v11
  v_mul_u32_u24 v12, 10, v11
  v_sub_u32 v12, v10, v12
  v_mul_u32_u24 v11, 1152, v11
  v_lshl_add_u32 v147, v12, 4, v11
  v_add_u32 v10, 256, v1
  v_mul_u32_u24 v11, 6554, v10
  v_lshrrev_b32 v11, 16, v11
  v_mul_u32_u24 v12, 10, v11
  v_sub_u32 v12, v10, v12
  v_mul_u32_u24 v11, 1152, v11
  v_lshl_add_u32 v148, v12, 4, v11
  s_cmp_lt_u32 s70, 21
  s_cselect_b32 s88, 1, 0
  s_cmp_lt_u32 s3, 4
  s_cselect_b32 s88, s88, 0
  s_mov_b32 s87, s88
  s_sub_u32 s75, s5, 28
  s_lshl_b32 s75, s75, 1
  s_sub_u32 s57, s3, 4
  s_add_u32 s75, s75, s57
  s_cmp_lt_u32 s57, 2
  s_cselect_b32 s75, s75, 99
  s_cmp_ge_u32 s5, 28
  s_cselect_b32 s75, s75, 99
  s_mov_b32 s74, 0
  s_cmp_eq_u32 s86, 1
  s_cbranch_scc1 L_prepret1
  s_cmp_eq_u32 s86, 2
  s_cbranch_scc1 L_prepret2
  s_cmp_eq_u32 s86, 3
  s_cbranch_scc1 L_prepret3
  s_waitcnt vmcnt(0)
  s_mov_b32 s57, 0
L_tag_29:
  v_readfirstlane_b32 s56, v17
  s_cmp_eq_u32 s56, 0
  s_cbranch_scc1 L_taga_31
  s_sub_u32 s91, s56, s90
  s_cmp_gt_i32 s91, -1000
  s_cbranch_scc1 L_tagd_30
  s_cmp_gt_u32 s57, 64
  s_cbranch_scc1 L_tagd_30
L_taga_31:
  s_add_u32 s57, s57, 1
  s_cmp_gt_u32 s57, 400000
  s_cbranch_scc1 L_end
  global_load_dword v17, v18, s[36:37] sc1
  s_waitcnt vmcnt(0)
  s_branch L_tag_29
L_tagd_30:
  v_mov_b32 v17, s56
L_p2b:
  s_lshr_b32 s57, s3, 2
  s_setprio 1
  s_cmp_eq_u32 s57, 0
  s_cbranch_scc1 L_apr
  s_setprio 2
L_apr:
  v_mov_b32 v12, 160512
  s_mov_b32 s58, 0
L_cnt_32:
  ds_read_b32 v13, v12
  s_add_u32 s58, s58, 1
  s_cmp_gt_u32 s58, 8000000
  s_cbranch_scc1 L_end
  s_waitcnt lgkmcnt(0)
  v_readfirstlane_b32 s57, v13
  s_cmp_lt_u32 s57, 4
  s_cbranch_scc1 L_cnt_32
  s_cmp_eq_u32 s81, 0
  s_cbranch_scc0 L_nosend1
  s_cmp_eq_u32 s3, 6
  s_cbranch_scc0 L_nosend1
  s_mov_b64 exec, 0xffff
  buffer_store_dword v17, v19, s[40:43], 0 offen sc1
  s_mov_b64 exec, -1
L_nosend1:
  buffer_load_dwordx4 v[56:59], v151, s[8:11], 0 offen
  buffer_load_ushort v60, v152, s[8:11], 0 offen offset:128
  buffer_load_dwordx2 v[154:155], v153, s[40:43], 0 offen sc1
  s_cmp_lt_u32 s3, 4
  s_cbranch_scc1 L_fetchv
  s_cmp_lt_u32 s3, 6
  s_cbranch_scc0 L_w67
L_wowin:
  s_mov_b32 m0, s73
  s_add_u32 s73, s73, 10240
  buffer_load_dwordx4 v144, s[52:55], s72 offen lds
  s_add_u32 m0, m0, 1024
  s_nop 0
  buffer_load_dwordx4 v145, s[52:55], s72 offen lds
  s_add_u32 m0, m0, 1024
  s_nop 0
  buffer_load_dwordx4 v146, s[52:55], s72 offen lds
  s_add_u32 m0, m0, 1024
  s_nop 0
  buffer_load_dwordx4 v147, s[52:55], s72 offen lds
  s_add_u32 m0, m0, 1024
  s_nop 0
  buffer_load_dwordx4 v148, s[52:55], s72 offen lds
  s_add_u32 s72, s72, 73728
L_wos_33:
  s_cmp_lt_u32 s73, 90368
  s_cbranch_scc1 L_wowin
L_w67:
  s_mov_b32 s73, 141568
  s_cmp_eq_u32 s3, 6
  s_cbranch_scc0 L_nocand6
  v_lshlrev_b32 v16, 4, v1
  s_mov_b32 s57, 65536
  buffer_load_dwordx4 v[248:251], v16, s[40:43], s57 offen sc1
  s_waitcnt vmcnt(0)
  s_mov_b32 s58, 0
L_cand_34:
  v_xor_b32 v249, v17, v249
  v_xor_b32 v251, v17, v251
  v_or_b32 v249, v249, v251
  v_cmp_eq_u32 vcc, 0, v249
  s_cmp_eq_u64 vcc, -1
  s_cbranch_scc1 L_candd_35
  s_add_u32 s58, s58, 1
  s_cmp_gt_u32 s58, 400000
  s_cbranch_scc1 L_end
  s_sleep 8
  s_mov_b32 s57, 65536
  buffer_load_dwordx4 v[248:251], v16, s[40:43], s57 offen sc1
  s_waitcnt vmcnt(0)
  s_branch L_cand_34
L_candd_35:
  v_max_u32 v248, v248, v250
  s_nop 1
  v_max_u32_dpp v248, v248, v248 row_ror:8 row_mask:0xf bank_mask:0xf
  s_nop 1
  v_max_u32_dpp v248, v248, v248 row_ror:4 row_mask:0xf bank_mask:0xf
  s_nop 1
  v_max_u32_dpp v248, v248, v248 row_ror:2 row_mask:0xf bank_mask:0xf
  s_nop 1
  v_max_u32_dpp v248, v248, v248 row_ror:1 row_mask:0xf bank_mask:0xf
  v_mov_b32 v249, v248
  s_nop 1
  v_permlane16_swap_b32 v248, v249
  v_max_u32 v248, v248, v249
  v_mov_b32 v249, v248
  s_nop 1
  v_permlane32_swap_b32 v248, v249
  v_max_u32 v248, v248, v249
  s_nop 0
  v_readfirstlane_b32 s84, v248
  s_and_b32 s83, s84, 0xffff
  s_sub_u32 s83, 2047, s83
  v_mov_b32 v12, 160520
  v_mov_b32 v13, s84
  ds_write_b32 v12, v13
  s_waitcnt lgkmcnt(0)
L_nocand6:
  s_cmp_eq_u32 s3, 7
  s_cbranch_scc0 L_fetch0
  s_mov_b64 exec, 0x3ff
  s_lshl_b32 s57, s77, 5
  s_add_u32 s57, s57, s76
  s_lshl_b32 s57, s57, 7
  s_cmp_eq_u32 s77, 0
  s_cselect_b32 s60, 0xcc, 0
  v_lshlrev_b32 v16, 2, v1
  v_mov_b32 v14, 160528
  s_add_u32 s59, s57, 32
  s_mov_b32 s58, 0
  s_cmp_eq_u32 s81, 0
  s_cbranch_scc1 L_poll1
  s_sleep 8
L_poll1:
  s_load_dwordx8 s[16:23], s[40:41], s57 glc
  s_load_dwordx2 s[24:25], s[40:41], s59 glc
  s_mov_b32 s61, 0
  s_waitcnt lgkmcnt(0)
  s_cmp_eq_u32 s25, s56
  s_addc_u32 s61, s61, s61
  s_cmp_eq_u32 s24, s56
  s_addc_u32 s61, s61, s61
  s_cmp_eq_u32 s23, s56
  s_addc_u32 s61, s61, s61
  s_cmp_eq_u32 s22, s56
  s_addc_u32 s61, s61, s61
  s_cmp_eq_u32 s21, s56
  s_addc_u32 s61, s61, s61
  s_cmp_eq_u32 s20, s56
  s_addc_u32 s61, s61, s61
  s_cmp_eq_u32 s19, s56
  s_addc_u32 s61, s61, s61
  s_cmp_eq_u32 s18, s56
  s_addc_u32 s61, s61, s61
  s_cmp_eq_u32 s17, s56
  s_addc_u32 s61, s61, s61
  s_cmp_eq_u32 s16, s56
  s_addc_u32 s61, s61, s61
  s_or_b32 s60, s61, s60
  s_add_u32 s61, s60, 1
  s_or_b32 s61, s61, s60
  s_cmp_eq_u32 s60, 0x3ff
  s_cselect_b32 s61, s61, s60
  v_mov_b32 v13, s61
  ds_write_b32 v14, v13
  s_cbranch_scc1 L_poll1x
  s_andn2_b32 exec_lo, 0x3ff, s60
  s_add_u32 s58, s58, 1
  s_cmp_gt_u32 s58, 400000
  s_cbranch_scc1 L_end
  s_sleep 4
  s_branch L_poll1
L_poll1x:
  s_mov_b64 exec, -1
  s_waitcnt lgkmcnt(0)
  s_branch L_fetch0
L_fetchv:
  s_lshr_b32 s59, s78, 2
  v_mov_b32 v12, 160528
  s_mov_b32 s58, 0
L_bw_36:
  ds_read_b32 v13, v12
  s_add_u32 s58, s58, 1
  s_cmp_gt_u32 s58, 8000000
  s_cbranch_scc1 L_end
  s_waitcnt lgkmcnt(0)
  v_readfirstlane_b32 s57, v13
  s_bitcmp1_b32 s57, s59
  s_cbranch_scc0 L_bw_36
  s_lshl_b32 s57, s76, 16
  s_add_u32 s57, s57, s67
  s_add_u32 s57, s57, 1048576
  buffer_load_dwordx4 v[20:23], v2, s[40:43], s57 offen sc1
  s_add_u32 s57, s92, s67
  s_lshr_b32 s57, s57, 1
  s_add_u32 s57, s57, s93
  s_add_u32 s57, s57, 7340032
  buffer_load_dword v24, v8, s[40:43], s57 offen sc1
  v_mov_b32 v12, 160532
  s_mov_b32 s58, 0
L_cnt_37:
  ds_read_b32 v13, v12
  s_add_u32 s58, s58, 1
  s_cmp_gt_u32 s58, 8000000
  s_cbranch_scc1 L_end
  s_waitcnt lgkmcnt(0)
  v_readfirstlane_b32 s57, v13
  s_cmp_lt_u32 s57, 4
  s_cbranch_scc1 L_cnt_37
  s_mov_b32 s62, s3
  s_lshl_b32 s58, s77, 1
  s_add_u32 s58, s58, s62
  s_lshl_b32 s61, s62, 11
  s_lshl_b32 s64, s58, 10
  s_cmp_lt_u32 s58, 2
  s_cselect_b32 s58, 1073741824, s61
  s_cselect_b32 s64, 1073741824, s64
  s_add_u32 s63, s58, s68
  s_add_u32 s63, s63, 2097152
  s_add_u32 s64, s58, s69
  s_add_u32 s64, s64, 524288
  s_add_u32 m0, s61, 24576
  s_nop 0
  buffer_load_dwordx4 v3, s[40:43], s63 offen sc1 lds
  buffer_load_dwordx4 v3, s[40:43], s63 offen offset:1024 sc1 lds
  s_add_u32 m0, s61, 32832
  s_add_u32 s63, s63, 32768
  buffer_load_dwordx4 v3, s[40:43], s63 offen sc1 lds
  buffer_load_dwordx4 v3, s[40:43], s63 offen offset:1024 sc1 lds
  s_add_u32 m0, s61, 41088
  s_nop 0
  buffer_load_dwordx4 v3, s[40:43], s64 offen sc1 lds
  buffer_load_dwordx4 v3, s[40:43], s64 offen offset:1024 sc1 lds
  v_mov_b32 v25, 0
  v_mov_b32 v26, 0
  v_mov_b32 v27, 0
  v_mov_b32 v34, 0
  v_mov_b32 v35, 0
  v_mov_b32 v33, 0x3f803f80
  s_waitcnt vmcnt(6)
  s_branch L_ppi
L_fetch0:
  s_sub_u32 s62, s3, 4
L_fetch:
  s_add_u32 s59, s62, 2
  v_mov_b32 v12, 160528
  s_mov_b32 s58, 0
L_bw_38:
  ds_read_b32 v13, v12
  s_add_u32 s58, s58, 1
  s_cmp_gt_u32 s58, 8000000
  s_cbranch_scc1 L_end
  s_waitcnt lgkmcnt(0)
  v_readfirstlane_b32 s57, v13
  s_bitcmp1_b32 s57, s59
  s_cbranch_scc0 L_bw_38
  s_lshl_b32 s58, s77, 1
  s_add_u32 s58, s58, s62
  s_lshl_b32 s61, s62, 11
  s_lshl_b32 s64, s58, 10
  s_cmp_lt_u32 s58, 2
  s_cselect_b32 s58, 1073741824, s61
  s_cselect_b32 s64, 1073741824, s64
  s_add_u32 s63, s58, s68
  s_add_u32 s64, s64, s93
  s_add_u32 s64, s64, 7862272
  s_add_u32 m0, s61, 0
  s_nop 0
  buffer_load_dwordx4 v3, s[40:43], s63 offen sc1 lds
  buffer_load_dwordx4 v3, s[40:43], s63 offen offset:1024 sc1 lds
  s_add_u32 m0, s61, 8192
  s_add_u32 s63, s63, 32768
  buffer_load_dwordx4 v3, s[40:43], s63 offen sc1 lds
  buffer_load_dwordx4 v3, s[40:43], s63 offen offset:1024 sc1 lds
  s_lshr_b32 s61, s61, 1
  s_add_u32 m0, s61, 16384
  s_nop 0
  buffer_load_dwordx4 v3, s[40:43], s64 offen sc1 lds
  s_lshr_b32 s59, s78, 2
  v_mov_b32 v12, 160528
  s_mov_b32 s58, 0
L_bw_39:
  ds_read_b32 v13, v12
  s_add_u32 s58, s58, 1
  s_cmp_gt_u32 s58, 8000000
  s_cbranch_scc1 L_end
  s_waitcnt lgkmcnt(0)
  v_readfirstlane_b32 s57, v13
  s_bitcmp1_b32 s57, s59
  s_cbranch_scc0 L_bw_39
L_fetchq:
  s_lshl_b32 s57, s76, 16
  s_add_u32 s57, s57, s67
  s_add_u32 s57, s57, 1048576
  buffer_load_dwordx4 v[20:23], v2, s[40:43], s57 offen sc1
  s_add_u32 s57, s92, s67
  s_lshr_b32 s57, s57, 1
  s_add_u32 s57, s57, s93
  s_add_u32 s57, s57, 7340032
  buffer_load_dword v24, v8, s[40:43], s57 offen sc1
  v_mov_b32 v12, 160532
  v_mov_b32 v13, 1
  s_mov_b64 exec, 1
  ds_add_u32 v12, v13
  s_mov_b64 exec, -1
  v_mov_b32 v25, 0
  v_mov_b32 v26, 0
  v_mov_b32 v27, 0
  v_mov_b32 v34, 0
  v_mov_b32 v35, 0
  v_mov_b32 v33, 0x3f803f80
  s_cmp_lt_u32 s75, 8
  s_cbranch_scc0 L_noppi
  s_mov_b32 exec_hi, 0xf
  s_mul_i32 s57, s75, 576
  s_mul_i32 s60, s4, 73728
  s_add_u32 s57, s57, s60
  s_add_u32 s57, s57, 393216
  buffer_load_dwordx4 v[184:187], v3, s[40:43], s57 offen sc1
  s_add_u32 s57, s57, 4608
  buffer_load_dwordx4 v[188:191], v3, s[40:43], s57 offen sc1
  s_add_u32 s57, s57, 4608
  buffer_load_dwordx4 v[192:195], v3, s[40:43], s57 offen sc1
  s_add_u32 s57, s57, 4608
  buffer_load_dwordx4 v[196:199], v3, s[40:43], s57 offen sc1
  s_add_u32 s57, s57, 4608
  buffer_load_dwordx4 v[200:203], v3, s[40:43], s57 offen sc1
  s_add_u32 s57, s57, 4608
  buffer_load_dwordx4 v[204:207], v3, s[40:43], s57 offen sc1
  s_add_u32 s57, s57, 4608
  buffer_load_dwordx4 v[208:211], v3, s[40:43], s57 offen sc1
  s_add_u32 s57, s57, 4608
  buffer_load_dwordx4 v[212:215], v3, s[40:43], s57 offen sc1
  s_add_u32 s57, s57, 4608
  buffer_load_dwordx4 v[216:219], v3, s[40:43], s57 offen sc1
  s_add_u32 s57, s57, 4608
  buffer_load_dwordx4 v[220:223], v3, s[40:43], s57 offen sc1
  s_add_u32 s57, s57, 4608
  buffer_load_dwordx4 v[224:227], v3, s[40:43], s57 offen sc1
  s_add_u32 s57, s57, 4608
  buffer_load_dwordx4 v[228:231], v3, s[40:43], s57 offen sc1
  s_add_u32 s57, s57, 4608
  buffer_load_dwordx4 v[232:235], v3, s[40:43], s57 offen sc1
  s_add_u32 s57, s57, 4608
  buffer_load_dwordx4 v[236:239], v3, s[40:43], s57 offen sc1
  s_add_u32 s57, s57, 4608
  buffer_load_dwordx4 v[240:243], v3, s[40:43], s57 offen sc1
  s_add_u32 s57, s57, 4608
  buffer_load_dwordx4 v[244:247], v3, s[40:43], s57 offen sc1
  s_mov_b32 exec_hi, -1
  s_waitcnt vmcnt(16)
  s_branch L_ppi
L_noppi:
  s_waitcnt vmcnt(0)
L_ppi:
  s_barrier
  ds_read_b128 v[28:31], v4 offset:4096
  ds_read_b32 v32, v5 offset:2048
  s_waitcnt lgkmcnt(0)
  v_mfma_f32_32x32x16_bf16 v[64:79], v[28:31], v[20:23], v[112:127]
  v_mfma_f32_32x32x16_bf16 v[64:79], v[32:35], v[24:27], v[64:79]
  ds_read_b128 v[28:31], v4 offset:3584
  ds_read_b32 v32, v5 offset:1792
  v_mov_b32 v96, 0
  v_mov_b32 v97, 0
  v_mov_b32 v98, 0
  v_mov_b32 v99, 0
  v_mov_b32 v100, 0
  v_mov_b32 v101, 0
  v_mov_b32 v102, 0
  v_mov_b32 v103, 0
  v_mov_b32 v104, 0
  v_mov_b32 v105, 0
  v_mov_b32 v106, 0
  v_mov_b32 v107, 0
  v_mov_b32 v108, 0
  v_mov_b32 v109, 0
  v_mov_b32 v110, 0
  v_mov_b32 v111, 0
  v_max3_f32 v52, v64, v65, v66
  v_max3_f32 v53, v67, v68, v69
  v_max3_f32 v53, v53, v70, v71
  v_max3_f32 v52, v52, v72, v73
  v_max3_f32 v53, v53, v74, v75
  v_max3_f32 v52, v52, v76, v77
  v_max3_f32 v53, v53, v78, v79
L_p1done:
  v_max_f32 v52, v52, v53
  v_mov_b32 v53, v52
  s_nop 1
  v_permlane32_swap_b32 v52, v53
  v_max_f32 v52, v52, v53
  v_sub_f32 v52, 0, v52
  v_cvt_pk_bf16_f32 v53, v52, v52
  v_lshlrev_b32 v53, 16, v53
  v_sub_f32 v53, v52, v53
  v_cvt_pk_bf16_f32 v52, v52, v53
  v_and_b32 v25, v7, v52
  v_lshlrev_b32 v53, 16, v52
  v_and_b32 v52, 0xffff0000, v52
  v_add_f32 v52, v52, v53
  v_add_f32 v64, v52, v64
  v_add_f32 v65, v52, v65
  v_add_f32 v66, v52, v66
  v_add_f32 v67, v52, v67
  v_add_f32 v68, v52, v68
  v_add_f32 v69, v52, v69
  v_add_f32 v70, v52, v70
  v_add_f32 v71, v52, v71
  v_add_f32 v72, v52, v72
  v_add_f32 v73, v52, v73
  v_add_f32 v74, v52, v74
  v_add_f32 v75, v52, v75
  v_add_f32 v76, v52, v76
  v_add_f32 v77, v52, v77
  v_add_f32 v78, v52, v78
  v_add_f32 v79, v52, v79
  s_waitcnt lgkmcnt(0)
  v_mfma_f32_32x32x16_bf16 v[80:95], v[28:31], v[20:23], 0
  v_exp_f32 v64, v64
  v_exp_f32 v65, v65
  v_exp_f32 v66, v66
  v_exp_f32 v67, v67
  v_cvt_pk_bf16_f32 v44, v64, v65
  v_exp_f32 v68, v68
  v_cvt_pk_bf16_f32 v45, v66, v67
  v_exp_f32 v69, v69
  v_mfma_f32_32x32x16_bf16 v[80:95], v[32:35], v[24:27], v[80:95]
  ds_read_b128 v[28:31], v4 offset:3072
  ds_read_b32 v32, v5 offset:1536
  v_exp_f32 v70, v70
  v_exp_f32 v71, v71
  v_exp_f32 v72, v72
  v_cvt_pk_bf16_f32 v46, v68, v69
  v_cvt_pk_bf16_f32 v47, v70, v71
  v_exp_f32 v73, v73
  v_exp_f32 v74, v74
  v_exp_f32 v75, v75
  v_cvt_pk_bf16_f32 v48, v72, v73
  v_exp_f32 v76, v76
  v_exp_f32 v77, v77
  v_cvt_pk_bf16_f32 v49, v74, v75
  v_exp_f32 v78, v78
  v_exp_f32 v79, v79
  s_cmp_lg_u32 s74, 0
  s_cbranch_scc1 L_noav
  s_cmp_lt_u32 s75, 8
  s_cbranch_scc1 L_avb
  s_waitcnt vmcnt(0)
L_avb:
  s_barrier
  s_cmp_eq_u32 s77, 0
  s_cbranch_scc0 L_noav
L_early:
  s_cmp_ge_u32 s73, 141568
  s_cbranch_scc1 L_wos_40
  s_mov_b32 m0, s73
  s_add_u32 s73, s73, 20480
  buffer_load_dwordx4 v144, s[52:55], s72 offen lds
  s_add_u32 m0, m0, 1024
  s_nop 0
  buffer_load_dwordx4 v145, s[52:55], s72 offen lds
  s_add_u32 m0, m0, 1024
  s_nop 0
  buffer_load_dwordx4 v146, s[52:55], s72 offen lds
  s_add_u32 m0, m0, 1024
  s_nop 0
  buffer_load_dwordx4 v147, s[52:55], s72 offen lds
  s_add_u32 m0, m0, 1024
  s_nop 0
  buffer_load_dwordx4 v148, s[52:55], s72 offen lds
  s_add_u32 s72, s72, 147456
L_wos_40:
  s_cmp_lt_u32 s73, 141568
  s_cbranch_scc1 L_early
  s_cmp_lt_u32 s75, 8
  s_cbranch_scc0 L_nopp
  s_mov_b32 s58, 0
  s_mov_b32 exec_hi, 0xf
L_m2_poll:
  s_waitcnt vmcnt(0)
  v_xor_b32 v185, v17, v185
  v_xor_b32 v187, v17, v187
  v_xor_b32 v189, v17, v189
  v_xor_b32 v191, v17, v191
  v_or3_b32 v185, v185, v189, v191
  v_xor_b32 v193, v17, v193
  v_xor_b32 v195, v17, v195
  v_or3_b32 v185, v185, v193, v195
  v_xor_b32 v197, v17, v197
  v_xor_b32 v199, v17, v199
  v_or3_b32 v185, v185, v197, v199
  v_xor_b32 v201, v17, v201
  v_xor_b32 v203, v17, v203
  v_or3_b32 v185, v185, v201, v203
  v_xor_b32 v205, v17, v205
  v_xor_b32 v207, v17, v207
  v_or3_b32 v185, v185, v205, v207
  v_xor_b32 v209, v17, v209
  v_xor_b32 v211, v17, v211
  v_or3_b32 v185, v185, v209, v211
  v_xor_b32 v213, v17, v213
  v_xor_b32 v215, v17, v215
  v_or3_b32 v185, v185, v213, v215
  v_xor_b32 v217, v17, v217
  v_xor_b32 v219, v17, v219
  v_or3_b32 v185, v185, v217, v219
  v_xor_b32 v221, v17, v221
  v_xor_b32 v223, v17, v223
  v_or3_b32 v185, v185, v221, v223
  v_xor_b32 v225, v17, v225
  v_xor_b32 v227, v17, v227
  v_or3_b32 v185, v185, v225, v227
  v_xor_b32 v229, v17, v229
  v_xor_b32 v231, v17, v231
  v_or3_b32 v185, v185, v229, v231
  v_xor_b32 v233, v17, v233
  v_xor_b32 v235, v17, v235
  v_or3_b32 v185, v185, v233, v235
  v_xor_b32 v237, v17, v237
  v_xor_b32 v239, v17, v239
  v_or3_b32 v185, v185, v237, v239
  v_xor_b32 v241, v17, v241
  v_xor_b32 v243, v17, v243
  v_or3_b32 v185, v185, v241, v243
  v_xor_b32 v245, v17, v245
  v_xor_b32 v247, v17, v247
  v_or3_b32 v185, v185, v245, v247
  v_or_b32 v185, v185, v187
  v_cmp_eq_u32 vcc, 0, v185
  s_cmp_eq_u64 vcc, exec
  s_cbranch_scc1 L_m2_got
  s_add_u32 s58, s58, 1
  s_cmp_gt_u32 s58, 400000
  s_cbranch_scc1 L_end
  s_sleep 16
  s_mul_i32 s57, s75, 576
  s_mul_i32 s60, s4, 73728
  s_add_u32 s57, s57, s60
  s_add_u32 s57, s57, 393216
  buffer_load_dwordx4 v[184:187], v3, s[40:43], s57 offen sc1
  s_add_u32 s57, s57, 4608
  buffer_load_dwordx4 v[188:191], v3, s[40:43], s57 offen sc1
  s_add_u32 s57, s57, 4608
  buffer_load_dwordx4 v[192:195], v3, s[40:43], s57 offen sc1
  s_add_u32 s57, s57, 4608
  buffer_load_dwordx4 v[196:199], v3, s[40:43], s57 offen sc1
  s_add_u32 s57, s57, 4608
  buffer_load_dwordx4 v[200:203], v3, s[40:43], s57 offen sc1
  s_add_u32 s57, s57, 4608
  buffer_load_dwordx4 v[204:207], v3, s[40:43], s57 offen sc1
  s_add_u32 s57, s57, 4608
  buffer_load_dwordx4 v[208:211], v3, s[40:43], s57 offen sc1
  s_add_u32 s57, s57, 4608
  buffer_load_dwordx4 v[212:215], v3, s[40:43], s57 offen sc1
  s_add_u32 s57, s57, 4608
  buffer_load_dwordx4 v[216:219], v3, s[40:43], s57 offen sc1
  s_add_u32 s57, s57, 4608
  buffer_load_dwordx4 v[220:223], v3, s[40:43], s57 offen sc1
  s_add_u32 s57, s57, 4608
  buffer_load_dwordx4 v[224:227], v3, s[40:43], s57 offen sc1
  s_add_u32 s57, s57, 4608
  buffer_load_dwordx4 v[228:231], v3, s[40:43], s57 offen sc1
  s_add_u32 s57, s57, 4608
  buffer_load_dwordx4 v[232:235], v3, s[40:43], s57 offen sc1
  s_add_u32 s57, s57, 4608
  buffer_load_dwordx4 v[236:239], v3, s[40:43], s57 offen sc1
  s_add_u32 s57, s57, 4608
  buffer_load_dwordx4 v[240:243], v3, s[40:43], s57 offen sc1
  s_add_u32 s57, s57, 4608
  buffer_load_dwordx4 v[244:247], v3, s[40:43], s57 offen sc1
  s_branch L_m2_poll
L_m2_got:
  v_add_f32 v184, v184, v192
  v_add_f32 v186, v186, v194
  v_add_f32 v188, v188, v196
  v_add_f32 v190, v190, v198
  v_add_f32 v184, v184, v200
  v_add_f32 v186, v186, v202
  v_add_f32 v188, v188, v204
  v_add_f32 v190, v190, v206
  v_add_f32 v184, v184, v208
  v_add_f32 v186, v186, v210
  v_add_f32 v188, v188, v212
  v_add_f32 v190, v190, v214
  v_add_f32 v184, v184, v216
  v_add_f32 v186, v186, v218
  v_add_f32 v188, v188, v220
  v_add_f32 v190, v190, v222
  v_add_f32 v184, v184, v224
  v_add_f32 v186, v186, v226
  v_add_f32 v188, v188, v228
  v_add_f32 v190, v190, v230
  v_add_f32 v184, v184, v232
  v_add_f32 v186, v186, v234
  v_add_f32 v188, v188, v236
  v_add_f32 v190, v190, v238
  v_add_f32 v184, v184, v240
  v_add_f32 v186, v186, v242
  v_add_f32 v188, v188, v244
  v_add_f32 v190, v190, v246
  v_cvt_pk_bf16_f32 v184, v184, v184
  v_and_b32 v184, 0xffff0000, v184
  v_cvt_pk_bf16_f32 v188, v188, v188
  v_and_b32 v188, 0xffff0000, v188
  v_mul_f32 v192, 0xbfb8aa3b, v184
  v_exp_f32 v192, v192
  s_nop 0
  v_add_f32 v192, 1.0, v192
  v_rcp_f32 v192, v192
  s_nop 0
  v_mul_f32 v184, v184, v192
  v_cvt_pk_bf16_f32 v184, v184, v184
  v_and_b32 v184, 0xffff0000, v184
  v_mul_f32 v184, v184, v188
  v_cvt_pk_bf16_f32 v184, v184, v18
  v_mov_b32 v185, v17
  v_cvt_pk_bf16_f32 v186, v186, v186
  v_and_b32 v186, 0xffff0000, v186
  v_cvt_pk_bf16_f32 v190, v190, v190
  v_and_b32 v190, 0xffff0000, v190
  v_mul_f32 v192, 0xbfb8aa3b, v186
  v_exp_f32 v192, v192
  s_nop 0
  v_add_f32 v192, 1.0, v192
  v_rcp_f32 v192, v192
  s_nop 0
  v_mul_f32 v186, v186, v192
  v_cvt_pk_bf16_f32 v186, v186, v186
  v_and_b32 v186, 0xffff0000, v186
  v_mul_f32 v186, v186, v190
  v_cvt_pk_bf16_f32 v186, v186, v18
  v_mov_b32 v187, v17
  s_mul_i32 s57, s75, 576
  v_add_u32 v192, s57, v3
  s_lshl_b32 s57, s4, 12
  s_add_u32 s57, s57, 163840
  s_mul_i32 s60, s4, 3584
  s_sub_u32 s60, 28672, s60
  v_subrev_u32 v193, 4096, v192
  v_ashrrev_i32 v193, 31, v193
  v_bfi_b32 v193, v193, 0, s60
  v_add_u32 v192, v192, v193
  buffer_store_dwordx4 v[184:187], v192, s[40:43], s57 offen sc1
  s_mov_b32 exec_hi, -1
L_nopp:
L_noav:
  ds_read_b64_tr_b16 v[36:37], v6 offset:4096
  ds_read_b64_tr_b16 v[38:39], v6 offset:4224
  ds_read_b64_tr_b16 v[40:41], v6 offset:4352
  ds_read_b64_tr_b16 v[42:43], v6 offset:4480
  v_cvt_pk_bf16_f32 v50, v76, v77
  s_waitcnt lgkmcnt(2)
  v_mfma_f32_32x32x16_bf16 v[96:111], v[36:39], v[44:47], v[96:111]
  s_cmp_eq_u32 s82, 8
  v_cvt_pk_bf16_f32 v51, v78, v79
  s_cbranch_scc1 L_p2done
  s_cmp_ge_u32 s73, 141568
  s_cbranch_scc1 L_wos_41
  s_mov_b32 m0, s73
  s_add_u32 s73, s73, 20480
  buffer_load_dwordx4 v144, s[52:55], s72 offen lds
  s_add_u32 m0, m0, 1024
  s_nop 0
  buffer_load_dwordx4 v145, s[52:55], s72 offen lds
  s_add_u32 m0, m0, 1024
  s_nop 0
  buffer_load_dwordx4 v146, s[52:55], s72 offen lds
  s_add_u32 m0, m0, 1024
  s_nop 0
  buffer_load_dwordx4 v147, s[52:55], s72 offen lds
  s_add_u32 m0, m0, 1024
  s_nop 0
  buffer_load_dwordx4 v148, s[52:55], s72 offen lds
  s_add_u32 s72, s72, 147456
L_wos_41:
  ds_read_b64_tr_b16 v[36:37], v6 offset:3584
  ds_read_b64_tr_b16 v[38:39], v6 offset:3712
  s_waitcnt lgkmcnt(2)
  v_mfma_f32_32x32x16_bf16 v[64:79], v[28:31], v[20:23], 0
  v_exp_f32 v80, v80
  v_exp_f32 v81, v81
  v_exp_f32 v82, v82
  v_exp_f32 v83, v83
  v_mfma_f32_32x32x16_bf16 v[96:111], v[40:43], v[48:51], v[96:111]
  ds_read_b64_tr_b16 v[40:41], v6 offset:3840
  ds_read_b64_tr_b16 v[42:43], v6 offset:3968
  v_cvt_pk_bf16_f32 v44, v80, v81
  v_exp_f32 v84, v84
  v_cvt_pk_bf16_f32 v45, v82, v83
  v_exp_f32 v85, v85
  v_mfma_f32_32x32x16_bf16 v[64:79], v[32:35], v[24:27], v[64:79]
  ds_read_b128 v[28:31], v4 offset:2560
  ds_read_b32 v32, v5 offset:1280
  v_exp_f32 v86, v86
  v_exp_f32 v87, v87
  v_exp_f32 v88, v88
  v_cvt_pk_bf16_f32 v46, v84, v85
  s_waitcnt lgkmcnt(4)
  v_cvt_pk_bf16_f32 v47, v86, v87
  v_exp_f32 v89, v89
  v_exp_f32 v90, v90
  v_mfma_f32_32x32x16_bf16 v[96:111], v[36:39], v[44:47], v[96:111]
  v_exp_f32 v91, v91
  v_cvt_pk_bf16_f32 v48, v88, v89
  v_exp_f32 v92, v92
  v_exp_f32 v93, v93
  v_cvt_pk_bf16_f32 v49, v90, v91
  v_exp_f32 v94, v94
  v_exp_f32 v95, v95
  v_cvt_pk_bf16_f32 v50, v92, v93
  s_cmp_eq_u32 s82, 7
  v_cvt_pk_bf16_f32 v51, v94, v95
  s_cbranch_scc1 L_p2done
  s_cmp_ge_u32 s73, 141568
  s_cbranch_scc1 L_wos_42
  s_mov_b32 m0, s73
  s_add_u32 s73, s73, 20480
  buffer_load_dwordx4 v144, s[52:55], s72 offen lds
  s_add_u32 m0, m0, 1024
  s_nop 0
  buffer_load_dwordx4 v145, s[52:55], s72 offen lds
  s_add_u32 m0, m0, 1024
  s_nop 0
  buffer_load_dwordx4 v146, s[52:55], s72 offen lds
  s_add_u32 m0, m0, 1024
  s_nop 0
  buffer_load_dwordx4 v147, s[52:55], s72 offen lds
  s_add_u32 m0, m0, 1024
  s_nop 0
  buffer_load_dwordx4 v148, s[52:55], s72 offen lds
  s_add_u32 s72, s72, 147456
L_wos_42:
  ds_read_b64_tr_b16 v[36:37], v6 offset:3072
  ds_read_b64_tr_b16 v[38:39], v6 offset:3200
  s_waitcnt lgkmcnt(2)
  v_mfma_f32_32x32x16_bf16 v[80:95], v[28:31], v[20:23], 0
  v_exp_f32 v64, v64
  v_exp_f32 v65, v65
  v_exp_f32 v66, v66
  v_exp_f32 v67, v67
  v_mfma_f32_32x32x16_bf16 v[96:111], v[40:43], v[48:51], v[96:111]
  ds_read_b64_tr_b16 v[40:41], v6 offset:3328
  ds_read_b64_tr_b16 v[42:43], v6 offset:3456
  v_cvt_pk_bf16_f32 v44, v64, v65
  v_exp_f32 v68, v68
  v_cvt_pk_bf16_f32 v45, v66, v67
  v_exp_f32 v69, v69
  v_mfma_f32_32x32x16_bf16 v[80:95], v[32:35], v[24:27], v[80:95]
  ds_read_b128 v[28:31], v4 offset:2048
  ds_read_b32 v32, v5 offset:1024
  v_exp_f32 v70, v70
  v_exp_f32 v71, v71
  v_exp_f32 v72, v72
  v_cvt_pk_bf16_f32 v46, v68, v69
  s_waitcnt lgkmcnt(4)
  v_cvt_pk_bf16_f32 v47, v70, v71
  v_exp_f32 v73, v73
  v_exp_f32 v74, v74
  v_mfma_f32_32x32x16_bf16 v[96:111], v[36:39], v[44:47], v[96:111]
  v_exp_f32 v75, v75
  v_cvt_pk_bf16_f32 v48, v72, v73
  v_exp_f32 v76, v76
  v_exp_f32 v77, v77
  v_cvt_pk_bf16_f32 v49, v74, v75
  v_exp_f32 v78, v78
  v_exp_f32 v79, v79
  v_cvt_pk_bf16_f32 v50, v76, v77
  s_cmp_eq_u32 s82, 6
  v_cvt_pk_bf16_f32 v51, v78, v79
  s_cbranch_scc1 L_p2done
  s_cmp_eq_u32 s87, 0
  s_cbranch_scc1 L_dn_43
  s_mov_b32 s87, 0
  s_lshl_b32 s57, s71, 7
  buffer_load_dwordx4 v[184:187], v54, s[48:51], s57 offen nt
  s_add_u32 s57, s57, 9216
  buffer_load_dwordx4 v[188:191], v54, s[48:51], s57 offen nt
  s_add_u32 s57, s57, 9216
  buffer_load_dwordx4 v[192:195], v54, s[48:51], s57 offen nt
  s_add_u32 s57, s57, 9216
  buffer_load_dwordx4 v[196:199], v54, s[48:51], s57 offen nt
  s_add_u32 s57, s57, 9216
  buffer_load_dwordx4 v[200:203], v54, s[48:51], s57 offen nt
  s_add_u32 s57, s57, 9216
  buffer_load_dwordx4 v[204:207], v54, s[48:51], s57 offen nt
  s_add_u32 s57, s57, 9216
  buffer_load_dwordx4 v[208:211], v54, s[48:51], s57 offen nt
L_dn_43:
  ds_read_b64_tr_b16 v[36:37], v6 offset:2560
  ds_read_b64_tr_b16 v[38:39], v6 offset:2688
  s_waitcnt lgkmcnt(2)
  v_mfma_f32_32x32x16_bf16 v[64:79], v[28:31], v[20:23], 0
  v_exp_f32 v80, v80
  v_exp_f32 v81, v81
  v_exp_f32 v82, v82
  v_exp_f32 v83, v83
  v_mfma_f32_32x32x16_bf16 v[96:111], v[40:43], v[48:51], v[96:111]
  ds_read_b64_tr_b16 v[40:41], v6 offset:2816
  ds_read_b64_tr_b16 v[42:43], v6 offset:2944
  v_cvt_pk_bf16_f32 v44, v80, v81
  v_exp_f32 v84, v84
  v_cvt_pk_bf16_f32 v45, v82, v83
  v_exp_f32 v85, v85
  v_mfma_f32_32x32x16_bf16 v[64:79], v[32:35], v[24:27], v[64:79]
  ds_read_b128 v[28:31], v4 offset:1536
  ds_read_b32 v32, v5 offset:768
  v_exp_f32 v86, v86
  v_exp_f32 v87, v87
  v_exp_f32 v88, v88
  v_cvt_pk_bf16_f32 v46, v84, v85
  s_waitcnt lgkmcnt(4)
  v_cvt_pk_bf16_f32 v47, v86, v87
  v_exp_f32 v89, v89
  v_exp_f32 v90, v90
  v_mfma_f32_32x32x16_bf16 v[96:111], v[36:39], v[44:47], v[96:111]
  v_exp_f32 v91, v91
  v_cvt_pk_bf16_f32 v48, v88, v89
  v_exp_f32 v92, v92
  v_exp_f32 v93, v93
  v_cvt_pk_bf16_f32 v49, v90, v91
  v_exp_f32 v94, v94
  v_exp_f32 v95, v95
  v_cvt_pk_bf16_f32 v50, v92, v93
  s_cmp_eq_u32 s82, 5
  v_cvt_pk_bf16_f32 v51, v94, v95
  s_cbranch_scc1 L_p2done
  s_cmp_lt_u32 s3, 4
  s_cbranch_scc1 L_pd_44
  s_setprio 0
L_pd_44:
  ds_read_b64_tr_b16 v[36:37], v6 offset:2048
  ds_read_b64_tr_b16 v[38:39], v6 offset:2176
  s_waitcnt lgkmcnt(2)
  v_mfma_f32_32x32x16_bf16 v[80:95], v[28:31], v[20:23], 0
  v_exp_f32 v64, v64
  v_exp_f32 v65, v65
  v_exp_f32 v66, v66
  v_exp_f32 v67, v67
  v_mfma_f32_32x32x16_bf16 v[96:111], v[40:43], v[48:51], v[96:111]
  ds_read_b64_tr_b16 v[40:41], v6 offset:2304
  ds_read_b64_tr_b16 v[42:43], v6 offset:2432
  v_cvt_pk_bf16_f32 v44, v64, v65
  v_exp_f32 v68, v68
  v_cvt_pk_bf16_f32 v45, v66, v67
  v_exp_f32 v69, v69
  v_mfma_f32_32x32x16_bf16 v[80:95], v[32:35], v[24:27], v[80:95]
  ds_read_b128 v[28:31], v4 offset:1024
  ds_read_b32 v32, v5 offset:512
  v_exp_f32 v70, v70
  v_exp_f32 v71, v71
  v_exp_f32 v72, v72
  v_cvt_pk_bf16_f32 v46, v68, v69
  s_waitcnt lgkmcnt(4)
  v_cvt_pk_bf16_f32 v47, v70, v71
  v_exp_f32 v73, v73
  v_exp_f32 v74, v74
  v_mfma_f32_32x32x16_bf16 v[96:111], v[36:39], v[44:47], v[96:111]
  v_exp_f32 v75, v75
  v_cvt_pk_bf16_f32 v48, v72, v73
  v_exp_f32 v76, v76
  v_exp_f32 v77, v77
  v_cvt_pk_bf16_f32 v49, v74, v75
  v_exp_f32 v78, v78
  v_exp_f32 v79, v79
  v_cvt_pk_bf16_f32 v50, v76, v77
  s_cmp_eq_u32 s82, 4
  v_cvt_pk_bf16_f32 v51, v78, v79
  s_cbranch_scc1 L_p2done
  s_cmp_ge_u32 s73, 141568
  s_cbranch_scc1 L_wos_45
  s_mov_b32 m0, s73
  s_add_u32 s73, s73, 20480
  buffer_load_dwordx4 v144, s[52:55], s72 offen lds
  s_add_u32 m0, m0, 1024
  s_nop 0
  buffer_load_dwordx4 v145, s[52:55], s72 offen lds
  s_add_u32 m0, m0, 1024
  s_nop 0
  buffer_load_dwordx4 v146, s[52:55], s72 offen lds
  s_add_u32 m0, m0, 1024
  s_nop 0
  buffer_load_dwordx4 v147, s[52:55], s72 offen lds
  s_add_u32 m0, m0, 1024
  s_nop 0
  buffer_load_dwordx4 v148, s[52:55], s72 offen lds
  s_add_u32 s72, s72, 147456
L_wos_45:
  ds_read_b64_tr_b16 v[36:37], v6 offset:1536
  ds_read_b64_tr_b16 v[38:39], v6 offset:1664
  s_waitcnt lgkmcnt(2)
  v_mfma_f32_32x32x16_bf16 v[64:79], v[28:31], v[20:23], 0
  v_exp_f32 v80, v80
  v_exp_f32 v81, v81
  v_exp_f32 v82, v82
  v_exp_f32 v83, v83
  v_mfma_f32_32x32x16_bf16 v[96:111], v[40:43], v[48:51], v[96:111]
  ds_read_b64_tr_b16 v[40:41], v6 offset:1792
  ds_read_b64_tr_b16 v[42:43], v6 offset:1920
  v_cvt_pk_bf16_f32 v44, v80, v81
  v_exp_f32 v84, v84
  v_cvt_pk_bf16_f32 v45, v82, v83
  v_exp_f32 v85, v85
  v_mfma_f32_32x32x16_bf16 v[64:79], v[32:35], v[24:27], v[64:79]
  ds_read_b128 v[28:31], v4 offset:512
  ds_read_b32 v32, v5 offset:256
  v_exp_f32 v86, v86
  v_exp_f32 v87, v87
  v_exp_f32 v88, v88
  v_cvt_pk_bf16_f32 v46, v84, v85
  s_waitcnt lgkmcnt(4)
  v_cvt_pk_bf16_f32 v47, v86, v87
  v_exp_f32 v89, v89
  v_exp_f32 v90, v90
  v_mfma_f32_32x32x16_bf16 v[96:111], v[36:39], v[44:47], v[96:111]
  v_exp_f32 v91, v91
  v_cvt_pk_bf16_f32 v48, v88, v89
  v_exp_f32 v92, v92
  v_exp_f32 v93, v93
  v_cvt_pk_bf16_f32 v49, v90, v91
  v_exp_f32 v94, v94
  v_exp_f32 v95, v95
  v_cvt_pk_bf16_f32 v50, v92, v93
  s_cmp_eq_u32 s82, 3
  v_cvt_pk_bf16_f32 v51, v94, v95
  s_cbranch_scc1 L_p2done
  ds_read_b64_tr_b16 v[36:37], v6 offset:1024
  ds_read_b64_tr_b16 v[38:39], v6 offset:1152
  s_waitcnt lgkmcnt(2)
  v_mfma_f32_32x32x16_bf16 v[80:95], v[28:31], v[20:23], 0
  v_exp_f32 v64, v64
  v_exp_f32 v65, v65
  v_exp_f32 v66, v66
  v_exp_f32 v67, v67
  v_mfma_f32_32x32x16_bf16 v[96:111], v[40:43], v[48:51], v[96:111]
  ds_read_b64_tr_b16 v[40:41], v6 offset:1280
  ds_read_b64_tr_b16 v[42:43], v6 offset:1408
  v_cvt_pk_bf16_f32 v44, v64, v65
  v_exp_f32 v68, v68
  v_cvt_pk_bf16_f32 v45, v66, v67
  v_exp_f32 v69, v69
  v_mfma_f32_32x32x16_bf16 v[80:95], v[32:35], v[24:27], v[80:95]
  ds_read_b128 v[28:31], v4 offset:0
  ds_read_b32 v32, v5 offset:0
  v_exp_f32 v70, v70
  v_exp_f32 v71, v71
  v_exp_f32 v72, v72
  v_cvt_pk_bf16_f32 v46, v68, v69
  s_waitcnt lgkmcnt(4)
  v_cvt_pk_bf16_f32 v47, v70, v71
  v_exp_f32 v73, v73
  v_exp_f32 v74, v74
  v_mfma_f32_32x32x16_bf16 v[96:111], v[36:39], v[44:47], v[96:111]
  v_exp_f32 v75, v75
  v_cvt_pk_bf16_f32 v48, v72, v73
  v_exp_f32 v76, v76
  v_exp_f32 v77, v77
  v_cvt_pk_bf16_f32 v49, v74, v75
  v_exp_f32 v78, v78
  v_exp_f32 v79, v79
  v_cvt_pk_bf16_f32 v50, v76, v77
  s_cmp_eq_u32 s82, 2
  v_cvt_pk_bf16_f32 v51, v78, v79
  s_cbranch_scc1 L_p2done
  s_cmp_eq_u32 s88, 0
  s_cbranch_scc1 L_noh
  s_mov_b32 s57, 163840
  buffer_load_dwordx2 v[226:227], v55, s[40:43], s57 offen sc1
L_noh:
  ds_read_b64_tr_b16 v[36:37], v6 offset:512
  ds_read_b64_tr_b16 v[38:39], v6 offset:640
  s_waitcnt lgkmcnt(2)
  v_mfma_f32_32x32x16_bf16 v[64:79], v[28:31], v[20:23], v[128:143]
  v_exp_f32 v80, v80
  v_exp_f32 v81, v81
  v_exp_f32 v82, v82
  v_exp_f32 v83, v83
  v_mfma_f32_32x32x16_bf16 v[96:111], v[40:43], v[48:51], v[96:111]
  ds_read_b64_tr_b16 v[40:41], v6 offset:768
  ds_read_b64_tr_b16 v[42:43], v6 offset:896
  v_cvt_pk_bf16_f32 v44, v80, v81
  v_exp_f32 v84, v84
  v_cvt_pk_bf16_f32 v45, v82, v83
  v_exp_f32 v85, v85
  v_mfma_f32_32x32x16_bf16 v[64:79], v[32:35], v[24:27], v[64:79]
  v_exp_f32 v86, v86
  v_exp_f32 v87, v87
  v_exp_f32 v88, v88
  v_cvt_pk_bf16_f32 v46, v84, v85
  s_waitcnt lgkmcnt(2)
  v_cvt_pk_bf16_f32 v47, v86, v87
  v_exp_f32 v89, v89
  v_exp_f32 v90, v90
  v_mfma_f32_32x32x16_bf16 v[96:111], v[36:39], v[44:47], v[96:111]
  v_exp_f32 v91, v91
  v_cvt_pk_bf16_f32 v48, v88, v89
  v_exp_f32 v92, v92
  v_exp_f32 v93, v93
  v_cvt_pk_bf16_f32 v49, v90, v91
  v_exp_f32 v94, v94
  v_exp_f32 v95, v95
  v_cvt_pk_bf16_f32 v50, v92, v93
  s_cmp_eq_u32 s82, 1
  v_cvt_pk_bf16_f32 v51, v94, v95
  s_cbranch_scc1 L_p2done
  ds_read_b64_tr_b16 v[36:37], v6 offset:0
  ds_read_b64_tr_b16 v[38:39], v6 offset:128
  s_waitcnt lgkmcnt(2)
  v_exp_f32 v64, v64
  v_exp_f32 v65, v65
  v_exp_f32 v66, v66
  v_exp_f32 v67, v67
  v_mfma_f32_32x32x16_bf16 v[96:111], v[40:43], v[48:51], v[96:111]
  ds_read_b64_tr_b16 v[40:41], v6 offset:256
  ds_read_b64_tr_b16 v[42:43], v6 offset:384
  v_cvt_pk_bf16_f32 v44, v64, v65
  v_exp_f32 v68, v68
  v_cvt_pk_bf16_f32 v45, v66, v67
  v_exp_f32 v69, v69
  v_exp_f32 v70, v70
  v_exp_f32 v71, v71
  v_exp_f32 v72, v72
  v_cvt_pk_bf16_f32 v46, v68, v69
  s_waitcnt lgkmcnt(2)
  v_cvt_pk_bf16_f32 v47, v70, v71
  v_exp_f32 v73, v73
  v_exp_f32 v74, v74
  v_mfma_f32_32x32x16_bf16 v[96:111], v[36:39], v[44:47], v[96:111]
  v_exp_f32 v75, v75
  v_cvt_pk_bf16_f32 v48, v72, v73
  v_exp_f32 v76, v76
  v_exp_f32 v77, v77
  v_cvt_pk_bf16_f32 v49, v74, v75
  v_exp_f32 v78, v78
  v_exp_f32 v79, v79
  v_cvt_pk_bf16_f32 v50, v76, v77
  s_nop 0
  v_cvt_pk_bf16_f32 v51, v78, v79
L_p2done:
  s_waitcnt lgkmcnt(0)
  s_nop 0
  v_mfma_f32_32x32x16_bf16 v[96:111], v[40:43], v[48:51], v[96:111]
  s_lshl_b32 s57, s76, 16
  s_add_u32 s57, s57, s67
  s_add_u32 s57, s57, 8912896
  s_lshl_b32 s58, s76, 13
  s_lshr_b32 s59, s67, 2
  s_add_u32 s58, s58, s59
  s_add_u32 s58, s58, 11010048
  s_nop 4
  v_rcp_f32 v52, v106
  s_nop 0
  v_mul_f32 v64, v52, v96
  v_mul_f32 v65, v52, v97
  v_mul_f32 v66, v52, v98
  v_mul_f32 v67, v52, v99
  v_mul_f32 v68, v52, v100
  v_mul_f32 v69, v52, v101
  v_mul_f32 v70, v52, v102
  v_mul_f32 v71, v52, v103
  v_mul_f32 v72, v52, v104
  v_mul_f32 v73, v52, v105
  v_cvt_pk_bf16_f32 v44, v64, v65
  v_cvt_pk_bf16_f32 v45, v66, v67
  v_cvt_pk_bf16_f32 v46, v68, v69
  v_cvt_pk_bf16_f32 v47, v70, v71
  v_cvt_pk_bf16_f32 v48, v72, v73
  buffer_store_dwordx4 v[44:47], v2, s[40:43], s57 offen sc1
  buffer_store_dword v48, v9, s[40:43], s58 offen sc1
  s_mov_b32 s59, 0x71800000
  v_max3_f32 v53, abs(v96), abs(v97), abs(v98)
  v_max3_f32 v53, v53, abs(v99), abs(v100)
  v_max3_f32 v53, v53, abs(v101), abs(v102)
  v_max3_f32 v53, v53, abs(v103), abs(v104)
  v_max3_f32 v53, v53, abs(v105), abs(v106)
  v_cmp_gt_f32 vcc, s59, v53
  s_cmp_eq_u64 vcc, -1
  s_cbranch_scc1 L_p2ok
  s_cmp_eq_u32 s74, 0
  s_cbranch_scc1 L_exact
L_p2ok:
  s_setprio 0
L_worest:
  s_cmp_ge_u32 s73, 141568
  s_cbranch_scc1 L_wos_46
  s_mov_b32 m0, s73
  s_add_u32 s73, s73, 20480
  buffer_load_dwordx4 v144, s[52:55], s72 offen lds
  s_add_u32 m0, m0, 1024
  s_nop 0
  buffer_load_dwordx4 v145, s[52:55], s72 offen lds
  s_add_u32 m0, m0, 1024
  s_nop 0
  buffer_load_dwordx4 v146, s[52:55], s72 offen lds
  s_add_u32 m0, m0, 1024
  s_nop 0
  buffer_load_dwordx4 v147, s[52:55], s72 offen lds
  s_add_u32 m0, m0, 1024
  s_nop 0
  buffer_load_dwordx4 v148, s[52:55], s72 offen lds
  s_add_u32 s72, s72, 147456
L_wos_46:
  s_cmp_lt_u32 s73, 141568
  s_cbranch_scc1 L_worest
  s_and_b32 s67, s3, 3
  s_lshr_b32 s68, s3, 2
  v_and_b32 v12, 15, v1
  v_lshrrev_b32 v13, 4, v1
  v_lshlrev_b32 v2, 15, v13
  v_lshl_add_u32 v19, v12, 2, v2
  v_lshl_add_u32 v2, v12, 4, v2
  s_lshl_b32 s57, s67, 4
  v_add_u32 v6, s57, v12
  v_mul_u32_u24 v6, 336, v6
  v_lshl_add_u32 v6, v13, 4, v6
  s_mul_i32 s57, s68, 21504
  v_add_u32 v6, s57, v6
  s_lshl_b32 s58, s67, 4
  s_add_u32 s60, s79, s58
  v_bfe_u32 v16, v1, 2, 2
  v_mul_u32_u24 v5, 72, v13
  v_add3_u32 v5, v5, v16, 16
  v_lshrrev_b32 v4, 1, v13
  v_mul_u32_u24 v4, 20, v4
  v_and_b32 v13, 1, v13
  v_lshl_add_u32 v13, v13, 2, v16
  v_add_u32 v4, v4, v13
  v_and_b32 v13, 3, v1
  v_lshlrev_b32 v13, 3, v13
  s_mul_i32 s57, s68, 46080
  s_add_u32 s57, s57, 49408
  v_add_u32 v13, s57, v13
  s_movk_i32 s57, 160
  v_mad_u32_u24 v4, v4, s57, v13
  v_mad_u32_u24 v5, v5, s57, v13
  s_waitcnt vmcnt(0)
  v_mov_b32 v12, 160512
  v_mov_b32 v13, 1
  s_mov_b64 exec, 1
  ds_add_u32 v12, v13
  s_mov_b64 exec, -1
  s_cmp_lt_u32 s3, 4
  s_cbranch_scc0 L_nocw
  v_mov_b32 v12, 160516
  v_mov_b32 v13, 1
  s_mov_b64 exec, 1
  ds_add_u32 v12, v13
  s_mov_b64 exec, -1
L_nocw:
  s_cmp_eq_u32 s3, 6
  s_cbranch_scc0 L_nosend2
  v_mov_b32 v12, 160512
  s_mov_b32 s58, 0
L_cnt_47:
  ds_read_b32 v13, v12
  s_add_u32 s58, s58, 1
  s_cmp_gt_u32 s58, 8000000
  s_cbranch_scc1 L_end
  s_waitcnt lgkmcnt(0)
  v_readfirstlane_b32 s57, v13
  s_cmp_lt_u32 s57, 12
  s_cbranch_scc1 L_cnt_47
  s_lshl_b32 s57, s77, 12
  s_lshl_b32 s58, s76, 2
  s_add_u32 s57, s57, s58
  s_add_u32 s57, s57, 32768
  v_lshlrev_b32 v12, 7, v1
  s_mov_b64 exec, 0xffffffff
  buffer_store_dword v17, v12, s[40:43], s57 offen sc1
  s_mov_b64 exec, -1
L_nosend2:
  v_mov_b32 v7, v149
  v_mov_b32 v8, v150
  v_mov_b32 v9, v151
  v_mov_b32 v10, v152
  v_mov_b32 v14, v153
  v_mov_b32 v20, v56
  v_mov_b32 v21, v57
  v_mov_b32 v22, v58
  v_mov_b32 v23, v59
  v_mov_b32 v24, v60
  v_mov_b32 v34, v154
  v_mov_b32 v35, v155
  s_cmp_eq_u32 s88, 0
  s_cbranch_scc1 L_p3_main
  s_mov_b32 s58, 0
L_h_chk:
  s_waitcnt vmcnt(0)
  v_cmp_eq_u32 vcc, v17, v227
  s_cmp_eq_u64 vcc, -1
  s_cbranch_scc1 L_h_ok
  s_add_u32 s58, s58, 1
  s_cmp_gt_u32 s58, 400000
  s_cbranch_scc1 L_end
  s_sleep 8
  s_mov_b32 s57, 163840
  buffer_load_dwordx2 v[226:227], v55, s[40:43], s57 offen sc1
  s_branch L_h_chk
L_h_ok:
  v_lshrrev_b32 v12, 3, v1
  v_lshlrev_b32 v12, 2, v12
  ds_bpermute_b32 v212, v12, v226 offset:0
  ds_bpermute_b32 v214, v12, v226 offset:32
  ds_bpermute_b32 v216, v12, v226 offset:64
  ds_bpermute_b32 v218, v12, v226 offset:96
  ds_bpermute_b32 v220, v12, v226 offset:128
  ds_bpermute_b32 v222, v12, v226 offset:160
  ds_bpermute_b32 v224, v12, v226 offset:192
  s_waitcnt lgkmcnt(0)
  v_lshlrev_b32 v213, 16, v212
  v_dot2_f32_bf16 v40, v184, v212, 0
  v_dot2_f32_bf16 v42, v185, v212, 0
  v_dot2_f32_bf16 v44, v186, v212, 0
  v_dot2_f32_bf16 v46, v187, v212, 0
  v_dot2_f32_bf16 v41, v184, v213, 0
  v_dot2_f32_bf16 v43, v185, v213, 0
  v_dot2_f32_bf16 v45, v186, v213, 0
  v_dot2_f32_bf16 v47, v187, v213, 0
  v_lshlrev_b32 v215, 16, v214
  v_dot2_f32_bf16 v40, v188, v214, v40
  v_dot2_f32_bf16 v42, v189, v214, v42
  v_dot2_f32_bf16 v44, v190, v214, v44
  v_dot2_f32_bf16 v46, v191, v214, v46
  v_dot2_f32_bf16 v41, v188, v215, v41
  v_dot2_f32_bf16 v43, v189, v215, v43
  v_dot2_f32_bf16 v45, v190, v215, v45
  v_dot2_f32_bf16 v47, v191, v215, v47
  v_lshlrev_b32 v217, 16, v216
  v_dot2_f32_bf16 v40, v192, v216, v40
  v_dot2_f32_bf16 v42, v193, v216, v42
  v_dot2_f32_bf16 v44, v194, v216, v44
  v_dot2_f32_bf16 v46, v195, v216, v46
  v_dot2_f32_bf16 v41, v192, v217, v41
  v_dot2_f32_bf16 v43, v193, v217, v43
  v_dot2_f32_bf16 v45, v194, v217, v45
  v_dot2_f32_bf16 v47, v195, v217, v47
  v_lshlrev_b32 v219, 16, v218
  v_dot2_f32_bf16 v40, v196, v218, v40
  v_dot2_f32_bf16 v42, v197, v218, v42
  v_dot2_f32_bf16 v44, v198, v218, v44
  v_dot2_f32_bf16 v46, v199, v218, v46
  v_dot2_f32_bf16 v41, v196, v219, v41
  v_dot2_f32_bf16 v43, v197, v219, v43
  v_dot2_f32_bf16 v45, v198, v219, v45
  v_dot2_f32_bf16 v47, v199, v219, v47
  v_lshlrev_b32 v221, 16, v220
  v_dot2_f32_bf16 v40, v200, v220, v40
  v_dot2_f32_bf16 v42, v201, v220, v42
  v_dot2_f32_bf16 v44, v202, v220, v44
  v_dot2_f32_bf16 v46, v203, v220, v46
  v_dot2_f32_bf16 v41, v200, v221, v41
  v_dot2_f32_bf16 v43, v201, v221, v43
  v_dot2_f32_bf16 v45, v202, v221, v45
  v_dot2_f32_bf16 v47, v203, v221, v47
  v_lshlrev_b32 v223, 16, v222
  v_dot2_f32_bf16 v40, v204, v222, v40
  v_dot2_f32_bf16 v42, v205, v222, v42
  v_dot2_f32_bf16 v44, v206, v222, v44
  v_dot2_f32_bf16 v46, v207, v222, v46
  v_dot2_f32_bf16 v41, v204, v223, v41
  v_dot2_f32_bf16 v43, v205, v223, v43
  v_dot2_f32_bf16 v45, v206, v223, v45
  v_dot2_f32_bf16 v47, v207, v223, v47
  v_lshlrev_b32 v225, 16, v224
  v_dot2_f32_bf16 v40, v208, v224, v40
  v_dot2_f32_bf16 v42, v209, v224, v42
  v_dot2_f32_bf16 v44, v210, v224, v44
  v_dot2_f32_bf16 v46, v211, v224, v46
  v_dot2_f32_bf16 v41, v208, v225, v41
  v_dot2_f32_bf16 v43, v209, v225, v43
  v_dot2_f32_bf16 v45, v210, v225, v45
  v_dot2_f32_bf16 v47, v211, v225, v47
  v_and_b32 v48, 7, v1
  v_lshrrev_b32 v49, 4, v1
  v_lshlrev_b32 v49, 1, v49
  v_lshl_add_u32 v48, v48, 3, v49
  s_lshl_b32 s57, s3, 8
  s_add_u32 s57, s57, 160768
  v_lshl_add_u32 v48, v48, 2, s57
  v_permlane32_swap_b32 v40, v44
  v_permlane32_swap_b32 v41, v45
  v_permlane32_swap_b32 v42, v46
  v_permlane32_swap_b32 v43, v47
  v_add_f32 v40, v40, v44
  v_add_f32 v41, v41, v45
  v_add_f32 v42, v42, v46
  v_add_f32 v43, v43, v47
  s_nop 0
  v_permlane16_swap_b32 v40, v42
  v_permlane16_swap_b32 v41, v43
  v_add_f32 v40, v40, v42
  v_add_f32 v41, v41, v43
  s_nop 0
  v_add_f32_dpp v40, v40, v40 row_ror:8 row_mask:0xf bank_mask:0xf
  v_add_f32_dpp v41, v41, v41 row_ror:8 row_mask:0xf bank_mask:0xf
  ds_write_b64 v48, v[40:41]
  v_mov_b32 v12, 160524
  v_mov_b32 v13, 1
  s_waitcnt lgkmcnt(0)
  s_mov_b64 exec, 1
  ds_add_rtn_u32 v13, v12, v13
  s_mov_b64 exec, -1
  v_lshlrev_b32 v12, 2, v1
  v_add_u32 v12, 160768, v12
  s_waitcnt lgkmcnt(0)
  v_readfirstlane_b32 s57, v13
  s_cmp_eq_u32 s57, 3
  s_cbranch_scc0 L_p3_main
  ds_read_b32 v72, v12 offset:0
  ds_read_b32 v73, v12 offset:256
  ds_read_b32 v74, v12 offset:512
  ds_read_b32 v75, v12 offset:768
  s_mul_i32 s57, s70, 4608
  s_lshl_b32 s58, s71, 9
  s_add_u32 s57, s57, s58
  s_add_u32 s57, s57, 229376
  v_lshlrev_b32 v12, 3, v1
  s_waitcnt lgkmcnt(0)
  v_add_f32 v72, v72, v73
  v_add_f32 v72, v72, v74
  v_add_f32 v72, v72, v75
  v_mov_b32 v73, v17
  buffer_store_dwordx2 v[72:73], v12, s[40:43], s57 offen sc1
L_p3_main:
  v_mov_b32 v12, 160520
  ds_read_b32 v13, v12
  s_waitcnt lgkmcnt(0)
  v_readfirstlane_b32 s84, v13
  s_and_b32 s83, s84, 0xffff
  s_sub_u32 s83, 2047, s83
  s_sub_u32 s69, s83, s79
  v_mov_b32 v12, 160516
  s_mov_b32 s58, 0
L_cnt_48:
  ds_read_b32 v13, v12
  s_add_u32 s58, s58, 1
  s_cmp_gt_u32 s58, 8000000
  s_cbranch_scc1 L_end
  s_waitcnt lgkmcnt(0)
  v_readfirstlane_b32 s57, v13
  s_cmp_lt_u32 s57, 4
  s_cbranch_scc1 L_cnt_48
  s_add_u32 s57, s80, 0
  s_and_b32 s57, s57, 7
  s_mul_i32 s57, s57, 5760
  v_add_u32 v12, s57, v4
  ds_read_b64_tr_b16 v[92:93], v12 offset:0
  ds_read_b64_tr_b16 v[94:95], v12 offset:1280
  ds_read_b64_tr_b16 v[96:97], v12 offset:32
  ds_read_b64_tr_b16 v[98:99], v12 offset:1312
  ds_read_b64_tr_b16 v[100:101], v12 offset:64
  ds_read_b64_tr_b16 v[102:103], v12 offset:1344
  ds_read_b64_tr_b16 v[104:105], v12 offset:96
  ds_read_b64_tr_b16 v[106:107], v12 offset:1376
  ds_read_b64_tr_b16 v[108:109], v12 offset:128
  ds_read_b64_tr_b16 v[110:111], v12 offset:1408
  s_add_u32 s57, s80, 1
  s_and_b32 s57, s57, 7
  s_mul_i32 s57, s57, 5760
  v_add_u32 v13, s57, v4
  ds_read_b64_tr_b16 v[112:113], v13 offset:0
  ds_read_b64_tr_b16 v[114:115], v13 offset:1280
  ds_read_b64_tr_b16 v[116:117], v13 offset:32
  ds_read_b64_tr_b16 v[118:119], v13 offset:1312
  ds_read_b64_tr_b16 v[120:121], v13 offset:64
  ds_read_b64_tr_b16 v[122:123], v13 offset:1344
  ds_read_b64_tr_b16 v[124:125], v13 offset:96
  ds_read_b64_tr_b16 v[126:127], v13 offset:1376
  ds_read_b64_tr_b16 v[128:129], v13 offset:128
  ds_read_b64_tr_b16 v[130:131], v13 offset:1408
  s_add_u32 s57, s80, 2
  s_and_b32 s57, s57, 7
  s_mul_i32 s57, s57, 5760
  v_add_u32 v12, s57, v4
  ds_read_b64_tr_b16 v[132:133], v12 offset:0
  ds_read_b64_tr_b16 v[134:135], v12 offset:1280
  ds_read_b64_tr_b16 v[136:137], v12 offset:32
  ds_read_b64_tr_b16 v[138:139], v12 offset:1312
  ds_read_b64_tr_b16 v[140:141], v12 offset:64
  ds_read_b64_tr_b16 v[142:143], v12 offset:1344
  ds_read_b64_tr_b16 v[144:145], v12 offset:96
  ds_read_b64_tr_b16 v[146:147], v12 offset:1376
  ds_read_b64_tr_b16 v[148:149], v12 offset:128
  ds_read_b64_tr_b16 v[150:151], v12 offset:1408
  s_add_u32 s57, s80, 3
  s_and_b32 s57, s57, 7
  s_mul_i32 s57, s57, 5760
  v_add_u32 v13, s57, v4
  ds_read_b64_tr_b16 v[152:153], v13 offset:0
  ds_read_b64_tr_b16 v[154:155], v13 offset:1280
  ds_read_b64_tr_b16 v[156:157], v13 offset:32
  ds_read_b64_tr_b16 v[158:159], v13 offset:1312
  ds_read_b64_tr_b16 v[160:161], v13 offset:64
  ds_read_b64_tr_b16 v[162:163], v13 offset:1344
  ds_read_b64_tr_b16 v[164:165], v13 offset:96
  ds_read_b64_tr_b16 v[166:167], v13 offset:1376
  ds_read_b64_tr_b16 v[168:169], v13 offset:128
  ds_read_b64_tr_b16 v[170:171], v13 offset:1408
  s_add_u32 s57, s80, 4
  s_and_b32 s57, s57, 7
  s_mul_i32 s57, s57, 5760
  v_add_u32 v12, s57, v4
  ds_read_b64_tr_b16 v[172:173], v12 offset:0
  ds_read_b64_tr_b16 v[174:175], v12 offset:1280
  ds_read_b64_tr_b16 v[176:177], v12 offset:32
  ds_read_b64_tr_b16 v[178:179], v12 offset:1312
  ds_read_b64_tr_b16 v[180:181], v12 offset:64
  ds_read_b64_tr_b16 v[182:183], v12 offset:1344
  ds_read_b64_tr_b16 v[184:185], v12 offset:96
  ds_read_b64_tr_b16 v[186:187], v12 offset:1376
  ds_read_b64_tr_b16 v[188:189], v12 offset:128
  ds_read_b64_tr_b16 v[190:191], v12 offset:1408
  s_add_u32 s57, s80, 5
  s_and_b32 s57, s57, 7
  s_mul_i32 s57, s57, 5760
  v_add_u32 v13, s57, v4
  ds_read_b64_tr_b16 v[192:193], v13 offset:0
  ds_read_b64_tr_b16 v[194:195], v13 offset:1280
  ds_read_b64_tr_b16 v[196:197], v13 offset:32
  ds_read_b64_tr_b16 v[198:199], v13 offset:1312
  ds_read_b64_tr_b16 v[200:201], v13 offset:64
  ds_read_b64_tr_b16 v[202:203], v13 offset:1344
  ds_read_b64_tr_b16 v[204:205], v13 offset:96
  ds_read_b64_tr_b16 v[206:207], v13 offset:1376
  ds_read_b64_tr_b16 v[208:209], v13 offset:128
  ds_read_b64_tr_b16 v[210:211], v13 offset:1408
  s_add_u32 s57, s80, 6
  s_and_b32 s57, s57, 7
  s_mul_i32 s57, s57, 5760
  v_add_u32 v12, s57, v4
  ds_read_b64_tr_b16 v[212:213], v12 offset:0
  ds_read_b64_tr_b16 v[214:215], v12 offset:1280
  ds_read_b64_tr_b16 v[216:217], v12 offset:32
  ds_read_b64_tr_b16 v[218:219], v12 offset:1312
  ds_read_b64_tr_b16 v[220:221], v12 offset:64
  ds_read_b64_tr_b16 v[222:223], v12 offset:1344
  ds_read_b64_tr_b16 v[224:225], v12 offset:96
  ds_read_b64_tr_b16 v[226:227], v12 offset:1376
  ds_read_b64_tr_b16 v[228:229], v12 offset:128
  ds_read_b64_tr_b16 v[230:231], v12 offset:1408
  s_add_u32 s57, s80, 7
  s_and_b32 s57, s57, 7
  s_mul_i32 s57, s57, 5760
  v_add_u32 v13, s57, v4
  ds_read_b64_tr_b16 v[232:233], v13 offset:0
  ds_read_b64_tr_b16 v[234:235], v13 offset:1280
  ds_read_b64_tr_b16 v[236:237], v13 offset:32
  ds_read_b64_tr_b16 v[238:239], v13 offset:1312
  ds_read_b64_tr_b16 v[240:241], v13 offset:64
  ds_read_b64_tr_b16 v[242:243], v13 offset:1344
  ds_read_b64_tr_b16 v[244:245], v13 offset:96
  ds_read_b64_tr_b16 v[246:247], v13 offset:1376
  ds_read_b64_tr_b16 v[248:249], v13 offset:128
  ds_read_b64_tr_b16 v[250:251], v13 offset:1408
  s_cmp_eq_u32 s3, 7
  s_cbranch_scc0 L_nop2
  s_lshr_b32 s63, s79, 3
  s_add_u32 s63, s63, s80
  s_lshl_b32 s63, s63, 7
  s_add_u32 s63, s63, 32768
  v_and_b32 v16, 31, v1
  v_lshlrev_b32 v16, 2, v16
  buffer_load_dword v11, v16, s[40:43], s63 offen sc1
L_nop2:
  s_lshl_b32 s57, s68, 20
  s_lshl_b32 s58, s60, 4
  s_add_u32 s57, s57, s58
  s_add_u32 s57, s57, 8912896
  s_add_u32 s58, s80, 0
  s_and_b32 s58, s58, 7
  s_lshl_b32 s58, s58, 17
  s_add_u32 s8, s58, s57
  s_add_u32 s58, s80, 1
  s_and_b32 s58, s58, 7
  s_lshl_b32 s58, s58, 17
  s_add_u32 s9, s58, s57
  s_add_u32 s58, s80, 2
  s_and_b32 s58, s58, 7
  s_lshl_b32 s58, s58, 17
  s_add_u32 s10, s58, s57
  s_add_u32 s58, s80, 3
  s_and_b32 s58, s58, 7
  s_lshl_b32 s58, s58, 17
  s_add_u32 s11, s58, s57
  s_add_u32 s58, s80, 4
  s_and_b32 s58, s58, 7
  s_lshl_b32 s58, s58, 17
  s_add_u32 s12, s58, s57
  s_add_u32 s58, s80, 5
  s_and_b32 s58, s58, 7
  s_lshl_b32 s58, s58, 17
  s_add_u32 s13, s58, s57
  s_add_u32 s58, s80, 6
  s_and_b32 s58, s58, 7
  s_lshl_b32 s58, s58, 17
  s_add_u32 s14, s58, s57
  s_add_u32 s58, s80, 7
  s_and_b32 s58, s58, 7
  s_lshl_b32 s58, s58, 17
  s_add_u32 s15, s58, s57
  s_lshl_b32 s57, s68, 17
  s_lshl_b32 s58, s60, 2
  s_add_u32 s57, s57, s58
  s_add_u32 s48, s57, 11010048
  s_add_u32 s49, s57, 11018240
  s_add_u32 s50, s57, 11026432
  s_add_u32 s51, s57, 11034624
  s_mov_b32 s57, 0
L_gchk:
  v_cmp_eq_u32 vcc, v17, v35
  s_cmp_eq_u64 vcc, -1
  s_cbranch_scc1 L_gok
  s_add_u32 s57, s57, 1
  s_cmp_gt_u32 s57, 400000
  s_cbranch_scc1 L_end
  buffer_load_dwordx2 v[34:35], v14, s[40:43], 0 offen sc1
  s_waitcnt vmcnt(0)
  s_branch L_gchk
L_gok:
  v_sub_f32 v35, 1.0, v34
  v_cvt_pk_bf16_f32 v35, v35, v35
  v_and_b32 v35, 0xffff0000, v35
  v_lshlrev_b32 v25, 16, v20
  v_and_b32 v26, 0xffff0000, v20
  v_lshlrev_b32 v27, 16, v21
  v_and_b32 v28, 0xffff0000, v21
  v_lshlrev_b32 v29, 16, v22
  v_and_b32 v30, 0xffff0000, v22
  v_lshlrev_b32 v31, 16, v23
  v_and_b32 v32, 0xffff0000, v23
  v_lshlrev_b32 v33, 16, v24
  v_mul_f32 v25, v35, v25
  v_mul_f32 v26, v35, v26
  v_mul_f32 v27, v35, v27
  v_mul_f32 v28, v35, v28
  v_mul_f32 v29, v35, v29
  v_mul_f32 v30, v35, v30
  v_mul_f32 v31, v35, v31
  v_mul_f32 v32, v35, v32
  v_mul_f32 v33, v35, v33
  v_cvt_pk_bf16_f32 v72, v25, v26
  v_cvt_pk_bf16_f32 v73, v27, v28
  v_cvt_pk_bf16_f32 v74, v29, v30
  v_cvt_pk_bf16_f32 v75, v31, v32
  v_cvt_pk_bf16_f32 v33, v33, v33
  v_and_b32 v33, 0xffff0000, v33
  v_lshlrev_b32 v25, 16, v72
  v_and_b32 v26, 0xffff0000, v72
  v_lshlrev_b32 v27, 16, v73
  v_and_b32 v28, 0xffff0000, v73
  v_lshlrev_b32 v29, 16, v74
  v_and_b32 v30, 0xffff0000, v74
  v_lshlrev_b32 v31, 16, v75
  v_and_b32 v32, 0xffff0000, v75
  s_cmp_eq_u32 s3, 7
  s_cbranch_scc0 L_poll2d
  s_mov_b32 s58, 0
L_poll2:
  s_waitcnt vmcnt(0)
  v_cmp_eq_u32 vcc, v17, v11
  s_cmp_eq_u64 vcc, -1
  s_cbranch_scc1 L_poll2d
  s_add_u32 s58, s58, 1
  s_cmp_gt_u32 s58, 400000
  s_cbranch_scc1 L_end
  buffer_load_dword v11, v16, s[40:43], s63 offen sc1
  s_branch L_poll2
L_poll2d:
  s_waitcnt lgkmcnt(0)
  s_barrier
  buffer_load_dwordx4 v[36:39], v2, s[40:43], s8 offen sc1
  buffer_load_dwordx4 v[40:43], v2, s[40:43], s9 offen sc1
  buffer_load_dwordx4 v[44:47], v2, s[40:43], s10 offen sc1
  s_waitcnt vmcnt(2) lgkmcnt(0)
  buffer_load_dwordx4 v[48:51], v2, s[40:43], s11 offen sc1
  v_mfma_f32_16x16x32_bf16 v[72:75], v[92:95], v[36:39], 0
  v_mfma_f32_16x16x32_bf16 v[76:79], v[96:99], v[36:39], 0
  v_mfma_f32_16x16x32_bf16 v[80:83], v[100:103], v[36:39], 0
  v_mfma_f32_16x16x32_bf16 v[84:87], v[104:107], v[36:39], 0
  v_mfma_f32_16x16x32_bf16 v[88:91], v[108:111], v[36:39], 0
  ds_read_b64_tr_b16 v[92:93], v5 offset:0
  ds_read_b64_tr_b16 v[94:95], v5 offset:5760
  ds_read_b64_tr_b16 v[96:97], v5 offset:32
  ds_read_b64_tr_b16 v[98:99], v5 offset:5792
  ds_read_b64_tr_b16 v[100:101], v5 offset:64
  ds_read_b64_tr_b16 v[102:103], v5 offset:5824
  ds_read_b64_tr_b16 v[104:105], v5 offset:96
  ds_read_b64_tr_b16 v[106:107], v5 offset:5856
  ds_read_b64_tr_b16 v[108:109], v5 offset:128
  ds_read_b64_tr_b16 v[110:111], v5 offset:5888
  s_waitcnt vmcnt(2) lgkmcnt(0)
  buffer_load_dwordx4 v[52:55], v2, s[40:43], s12 offen sc1
  v_mfma_f32_16x16x32_bf16 v[72:75], v[112:115], v[40:43], v[72:75]
  v_mfma_f32_16x16x32_bf16 v[76:79], v[116:119], v[40:43], v[76:79]
  v_mfma_f32_16x16x32_bf16 v[80:83], v[120:123], v[40:43], v[80:83]
  v_mfma_f32_16x16x32_bf16 v[84:87], v[124:127], v[40:43], v[84:87]
  v_mfma_f32_16x16x32_bf16 v[88:91], v[128:131], v[40:43], v[88:91]
  s_waitcnt vmcnt(2) lgkmcnt(0)
  buffer_load_dwordx4 v[56:59], v2, s[40:43], s13 offen sc1
  v_mfma_f32_16x16x32_bf16 v[72:75], v[132:135], v[44:47], v[72:75]
  v_mfma_f32_16x16x32_bf16 v[76:79], v[136:139], v[44:47], v[76:79]
  v_mfma_f32_16x16x32_bf16 v[80:83], v[140:143], v[44:47], v[80:83]
  v_mfma_f32_16x16x32_bf16 v[84:87], v[144:147], v[44:47], v[84:87]
  v_mfma_f32_16x16x32_bf16 v[88:91], v[148:151], v[44:47], v[88:91]
  s_waitcnt vmcnt(2) lgkmcnt(0)
  buffer_load_dwordx4 v[60:63], v2, s[40:43], s14 offen sc1
  v_mfma_f32_16x16x32_bf16 v[72:75], v[152:155], v[48:51], v[72:75]
  v_mfma_f32_16x16x32_bf16 v[76:79], v[156:159], v[48:51], v[76:79]
  v_mfma_f32_16x16x32_bf16 v[80:83], v[160:163], v[48:51], v[80:83]
  v_mfma_f32_16x16x32_bf16 v[84:87], v[164:167], v[48:51], v[84:87]
  v_mfma_f32_16x16x32_bf16 v[88:91], v[168:171], v[48:51], v[88:91]
  s_waitcnt vmcnt(2) lgkmcnt(0)
  buffer_load_dwordx4 v[64:67], v2, s[40:43], s15 offen sc1
  v_mfma_f32_16x16x32_bf16 v[72:75], v[172:175], v[52:55], v[72:75]
  v_mfma_f32_16x16x32_bf16 v[76:79], v[176:179], v[52:55], v[76:79]
  v_mfma_f32_16x16x32_bf16 v[80:83], v[180:183], v[52:55], v[80:83]
  v_mfma_f32_16x16x32_bf16 v[84:87], v[184:187], v[52:55], v[84:87]
  v_mfma_f32_16x16x32_bf16 v[88:91], v[188:191], v[52:55], v[88:91]
  s_waitcnt vmcnt(2) lgkmcnt(0)
  buffer_load_dword v68, v19, s[40:43], s48 offen sc1
  buffer_load_dword v69, v19, s[40:43], s49 offen sc1
  buffer_load_dword v70, v19, s[40:43], s50 offen sc1
  buffer_load_dword v71, v19, s[40:43], s51 offen sc1
  v_mfma_f32_16x16x32_bf16 v[72:75], v[192:195], v[56:59], v[72:75]
  v_mfma_f32_16x16x32_bf16 v[76:79], v[196:199], v[56:59], v[76:79]
  v_mfma_f32_16x16x32_bf16 v[80:83], v[200:203], v[56:59], v[80:83]
  v_mfma_f32_16x16x32_bf16 v[84:87], v[204:207], v[56:59], v[84:87]
  v_mfma_f32_16x16x32_bf16 v[88:91], v[208:211], v[56:59], v[88:91]
  s_cmp_eq_u32 s3, 1
  s_cselect_b32 s57, s69, 64
  s_cmp_lt_u32 s57, 64
  s_cbranch_scc1 L_yfast
  s_waitcnt vmcnt(5) lgkmcnt(0)
  v_mfma_f32_16x16x32_bf16 v[72:75], v[212:215], v[60:63], v[72:75]
  v_mfma_f32_16x16x32_bf16 v[76:79], v[216:219], v[60:63], v[76:79]
  v_mfma_f32_16x16x32_bf16 v[80:83], v[220:223], v[60:63], v[80:83]
  v_mfma_f32_16x16x32_bf16 v[84:87], v[224:227], v[60:63], v[84:87]
  v_mfma_f32_16x16x32_bf16 v[88:91], v[228:231], v[60:63], v[88:91]
  s_waitcnt vmcnt(4) lgkmcnt(0)
  v_mfma_f32_16x16x32_bf16 v[72:75], v[232:235], v[64:67], v[72:75]
  v_mfma_f32_16x16x32_bf16 v[76:79], v[236:239], v[64:67], v[76:79]
  v_mfma_f32_16x16x32_bf16 v[80:83], v[240:243], v[64:67], v[80:83]
  v_mfma_f32_16x16x32_bf16 v[84:87], v[244:247], v[64:67], v[84:87]
  v_mfma_f32_16x16x32_bf16 v[88:91], v[248:251], v[64:67], v[88:91]
  s_waitcnt vmcnt(0) lgkmcnt(0)
  v_mfma_f32_16x16x32_bf16 v[72:75], v[92:95], v[68:71], v[72:75]
  v_mfma_f32_16x16x32_bf16 v[76:79], v[96:99], v[68:71], v[76:79]
  v_mfma_f32_16x16x32_bf16 v[80:83], v[100:103], v[68:71], v[80:83]
  v_mfma_f32_16x16x32_bf16 v[84:87], v[104:107], v[68:71], v[84:87]
  v_mfma_f32_16x16x32_bf16 v[88:91], v[108:111], v[68:71], v[88:91]
  s_cmp_lt_u32 s69, 64
  s_cbranch_scc0 L_noy1
  s_cmp_eq_u32 s3, 1
  s_cbranch_scc0 L_noy1
  s_mov_b32 exec_hi, 0xf
  s_mov_b32 s58, 0
L_polly:
  s_mul_i32 s57, s80, 576
  s_add_u32 s57, s57, 229376
  buffer_load_dwordx4 v[112:115], v3, s[40:43], s57 offen sc1
  s_add_u32 s57, s57, 4608
  buffer_load_dwordx4 v[116:119], v3, s[40:43], s57 offen sc1
  s_add_u32 s57, s57, 4608
  buffer_load_dwordx4 v[120:123], v3, s[40:43], s57 offen sc1
  s_add_u32 s57, s57, 4608
  buffer_load_dwordx4 v[124:127], v3, s[40:43], s57 offen sc1
  s_add_u32 s57, s57, 4608
  buffer_load_dwordx4 v[128:131], v3, s[40:43], s57 offen sc1
  s_add_u32 s57, s57, 4608
  buffer_load_dwordx4 v[132:135], v3, s[40:43], s57 offen sc1
  s_add_u32 s57, s57, 4608
  buffer_load_dwordx4 v[136:139], v3, s[40:43], s57 offen sc1
  s_add_u32 s57, s57, 4608
  buffer_load_dwordx4 v[140:143], v3, s[40:43], s57 offen sc1
  s_add_u32 s57, s57, 4608
  buffer_load_dwordx4 v[144:147], v3, s[40:43], s57 offen sc1
  s_add_u32 s57, s57, 4608
  buffer_load_dwordx4 v[148:151], v3, s[40:43], s57 offen sc1
  s_add_u32 s57, s57, 4608
  buffer_load_dwordx4 v[152:155], v3, s[40:43], s57 offen sc1
  s_add_u32 s57, s57, 4608
  buffer_load_dwordx4 v[156:159], v3, s[40:43], s57 offen sc1
  s_add_u32 s57, s57, 4608
  buffer_load_dwordx4 v[160:163], v3, s[40:43], s57 offen sc1
  s_add_u32 s57, s57, 4608
  buffer_load_dwordx4 v[164:167], v3, s[40:43], s57 offen sc1
  s_add_u32 s57, s57, 4608
  buffer_load_dwordx4 v[168:171], v3, s[40:43], s57 offen sc1
  s_add_u32 s57, s57, 4608
  buffer_load_dwordx4 v[172:175], v3, s[40:43], s57 offen sc1
  s_add_u32 s57, s57, 4608
  buffer_load_dwordx4 v[176:179], v3, s[40:43], s57 offen sc1
  s_add_u32 s57, s57, 4608
  buffer_load_dwordx4 v[180:183], v3, s[40:43], s57 offen sc1
  s_add_u32 s57, s57, 4608
  buffer_load_dwordx4 v[184:187], v3, s[40:43], s57 offen sc1
  s_add_u32 s57, s57, 4608
  buffer_load_dwordx4 v[188:191], v3, s[40:43], s57 offen sc1
  s_add_u32 s57, s57, 4608
  buffer_load_dwordx4 v[192:195], v3, s[40:43], s57 offen sc1
L_ygot:
  s_lshr_b32 s57, s84, 16
  s_bitcmp1_b32 s57, 15
  s_cselect_b32 s59, 0, 0x7fff
  s_xor_b32 s57, s57, s59
  s_xor_b32 s57, s57, 0x8000
  s_lshl_b32 s57, s57, 16
  v_mov_b32 v98, s57
  v_mul_f32 v99, 0xbfb8aa3b, v98
  v_exp_f32 v99, v99
  s_nop 0
  v_add_f32 v99, 1.0, v99
  v_rcp_f32 v99, v99
  s_nop 0
  v_cvt_pk_bf16_f32 v99, v99, v99
  v_and_b32 v99, 0xffff0000, v99
  v_mov_b32 v98, 0
  s_waitcnt vmcnt(14)
  v_xor_b32 v113, v17, v113
  v_xor_b32 v115, v17, v115
  v_or3_b32 v98, v98, v113, v115
  v_xor_b32 v117, v17, v117
  v_xor_b32 v119, v17, v119
  v_or3_b32 v98, v98, v117, v119
  v_add_f32 v112, v112, v116
  v_add_f32 v114, v114, v118
  v_xor_b32 v121, v17, v121
  v_xor_b32 v123, v17, v123
  v_or3_b32 v98, v98, v121, v123
  v_add_f32 v112, v112, v120
  v_add_f32 v114, v114, v122
  v_xor_b32 v125, v17, v125
  v_xor_b32 v127, v17, v127
  v_or3_b32 v98, v98, v125, v127
  v_add_f32 v112, v112, v124
  v_add_f32 v114, v114, v126
  v_xor_b32 v129, v17, v129
  v_xor_b32 v131, v17, v131
  v_or3_b32 v98, v98, v129, v131
  v_add_f32 v112, v112, v128
  v_add_f32 v114, v114, v130
  v_xor_b32 v133, v17, v133
  v_xor_b32 v135, v17, v135
  v_or3_b32 v98, v98, v133, v135
  v_add_f32 v112, v112, v132
  v_add_f32 v114, v114, v134
  v_xor_b32 v137, v17, v137
  v_xor_b32 v139, v17, v139
  v_or3_b32 v98, v98, v137, v139
  v_add_f32 v112, v112, v136
  v_add_f32 v114, v114, v138
  s_waitcnt vmcnt(7)
  v_xor_b32 v141, v17, v141
  v_xor_b32 v143, v17, v143
  v_or3_b32 v98, v98, v141, v143
  v_add_f32 v112, v112, v140
  v_add_f32 v114, v114, v142
  v_xor_b32 v145, v17, v145
  v_xor_b32 v147, v17, v147
  v_or3_b32 v98, v98, v145, v147
  v_add_f32 v112, v112, v144
  v_add_f32 v114, v114, v146
  v_xor_b32 v149, v17, v149
  v_xor_b32 v151, v17, v151
  v_or3_b32 v98, v98, v149, v151
  v_add_f32 v112, v112, v148
  v_add_f32 v114, v114, v150
  v_xor_b32 v153, v17, v153
  v_xor_b32 v155, v17, v155
  v_or3_b32 v98, v98, v153, v155
  v_add_f32 v112, v112, v152
  v_add_f32 v114, v114, v154
  v_xor_b32 v157, v17, v157
  v_xor_b32 v159, v17, v159
  v_or3_b32 v98, v98, v157, v159
  v_add_f32 v112, v112, v156
  v_add_f32 v114, v114, v158
  v_xor_b32 v161, v17, v161
  v_xor_b32 v163, v17, v163
  v_or3_b32 v98, v98, v161, v163
  v_add_f32 v112, v112, v160
  v_add_f32 v114, v114, v162
  v_xor_b32 v165, v17, v165
  v_xor_b32 v167, v17, v167
  v_or3_b32 v98, v98, v165, v167
  v_add_f32 v112, v112, v164
  v_add_f32 v114, v114, v166
  s_waitcnt vmcnt(0)
  v_xor_b32 v169, v17, v169
  v_xor_b32 v171, v17, v171
  v_or3_b32 v98, v98, v169, v171
  v_add_f32 v112, v112, v168
  v_add_f32 v114, v114, v170
  v_xor_b32 v173, v17, v173
  v_xor_b32 v175, v17, v175
  v_or3_b32 v98, v98, v173, v175
  v_add_f32 v112, v112, v172
  v_add_f32 v114, v114, v174
  v_xor_b32 v177, v17, v177
  v_xor_b32 v179, v17, v179
  v_or3_b32 v98, v98, v177, v179
  v_add_f32 v112, v112, v176
  v_add_f32 v114, v114, v178
  v_xor_b32 v181, v17, v181
  v_xor_b32 v183, v17, v183
  v_or3_b32 v98, v98, v181, v183
  v_add_f32 v112, v112, v180
  v_add_f32 v114, v114, v182
  v_xor_b32 v185, v17, v185
  v_xor_b32 v187, v17, v187
  v_or3_b32 v98, v98, v185, v187
  v_add_f32 v112, v112, v184
  v_add_f32 v114, v114, v186
  v_xor_b32 v189, v17, v189
  v_xor_b32 v191, v17, v191
  v_or3_b32 v98, v98, v189, v191
  v_add_f32 v112, v112, v188
  v_add_f32 v114, v114, v190
  v_xor_b32 v193, v17, v193
  v_xor_b32 v195, v17, v195
  v_or3_b32 v98, v98, v193, v195
  v_add_f32 v112, v112, v192
  v_add_f32 v114, v114, v194
  v_cmp_eq_u32 vcc, 0, v98
  s_cmp_eq_u64 vcc, exec
  s_cbranch_scc1 L_pollyd
  s_add_u32 s58, s58, 1
  s_cmp_gt_u32 s58, 400000
  s_cbranch_scc1 L_end
  s_sleep 4
  s_branch L_polly
L_pollyd:
  v_cvt_pk_bf16_f32 v98, v112, v114
  v_lshlrev_b32 v100, 16, v98
  v_and_b32 v101, 0xffff0000, v98
  v_mul_f32 v100, v99, v100
  v_mul_f32 v101, v99, v101
  v_cvt_pk_bf16_f32 v98, v100, v101
  v_lshlrev_b32 v100, 16, v98
  v_and_b32 v101, 0xffff0000, v98
  v_lshrrev_b32 v13, 1, v3
  ds_write_b64 v13, v[100:101] offset:43008
  s_mov_b64 exec, -1
L_noy1:
  s_nop 4
  ds_write_b128 v6, v[72:75] offset:0
  ds_write_b128 v6, v[76:79] offset:64
  ds_write_b128 v6, v[80:83] offset:128
  ds_write_b128 v6, v[84:87] offset:192
  ds_write_b128 v6, v[88:91] offset:256
  s_waitcnt lgkmcnt(0)
  s_barrier
  ds_read_b128 v[40:43], v7 offset:0
  ds_read_b128 v[50:53], v7 offset:21504
  ds_read_b128 v[44:47], v7 offset:16
  ds_read_b128 v[54:57], v7 offset:21520
  ds_read_b32 v48, v8 offset:256
  ds_read_b32 v58, v8 offset:21760
  s_cmp_lt_u32 s69, 64
  s_cbranch_scc0 L_noy2
  v_lshrrev_b32 v68, 3, v0
  v_cmp_eq_u32 vcc, s69, v68
  s_cbranch_vccz L_noy2
  v_and_b32 v68, 7, v0
  v_lshlrev_b32 v69, 5, v68
  v_lshlrev_b32 v68, 2, v68
  ds_read_b128 v[100:103], v69 offset:43008
  ds_read_b128 v[104:107], v69 offset:43024
  ds_read_b32 v108, v68 offset:43264
  s_mov_b64 exec, vcc
  v_lshlrev_b32 v25, 16, v20
  v_and_b32 v26, 0xffff0000, v20
  v_lshlrev_b32 v27, 16, v21
  v_and_b32 v28, 0xffff0000, v21
  v_lshlrev_b32 v29, 16, v22
  v_and_b32 v30, 0xffff0000, v22
  v_lshlrev_b32 v31, 16, v23
  v_and_b32 v32, 0xffff0000, v23
  v_lshlrev_b32 v33, 16, v24
  s_waitcnt lgkmcnt(0)
  v_add_f32 v25, v25, v100
  v_add_f32 v26, v26, v101
  v_add_f32 v27, v27, v102
  v_add_f32 v28, v28, v103
  v_add_f32 v29, v29, v104
  v_add_f32 v30, v30, v105
  v_add_f32 v31, v31, v106
  v_add_f32 v32, v32, v107
  v_add_f32 v33, v33, v108
  v_cvt_pk_bf16_f32 v64, v25, v26
  v_cvt_pk_bf16_f32 v65, v27, v28
  v_cvt_pk_bf16_f32 v66, v29, v30
  v_cvt_pk_bf16_f32 v67, v31, v32
  v_cvt_pk_bf16_f32 v33, v33, v33
  v_and_b32 v33, 0xffff0000, v33
  v_lshlrev_b32 v25, 16, v64
  v_and_b32 v26, 0xffff0000, v64
  v_lshlrev_b32 v27, 16, v65
  v_and_b32 v28, 0xffff0000, v65
  v_lshlrev_b32 v29, 16, v66
  v_and_b32 v30, 0xffff0000, v66
  v_lshlrev_b32 v31, 16, v67
  v_and_b32 v32, 0xffff0000, v67
  v_mul_f32 v25, v35, v25
  v_mul_f32 v26, v35, v26
  v_mul_f32 v27, v35, v27
  v_mul_f32 v28, v35, v28
  v_mul_f32 v29, v35, v29
  v_mul_f32 v30, v35, v30
  v_mul_f32 v31, v35, v31
  v_mul_f32 v32, v35, v32
  v_mul_f32 v33, v35, v33
  v_cvt_pk_bf16_f32 v64, v25, v26
  v_cvt_pk_bf16_f32 v65, v27, v28
  v_cvt_pk_bf16_f32 v66, v29, v30
  v_cvt_pk_bf16_f32 v67, v31, v32
  v_cvt_pk_bf16_f32 v33, v33, v33
  v_and_b32 v33, 0xffff0000, v33
  v_lshlrev_b32 v25, 16, v64
  v_and_b32 v26, 0xffff0000, v64
  v_lshlrev_b32 v27, 16, v65
  v_and_b32 v28, 0xffff0000, v65
  v_lshlrev_b32 v29, 16, v66
  v_and_b32 v30, 0xffff0000, v66
  v_lshlrev_b32 v31, 16, v67
  v_and_b32 v32, 0xffff0000, v67
  s_mov_b64 exec, -1
L_noy2:
  s_waitcnt lgkmcnt(0)
  v_add_f32 v40, v40, v50
  v_add_f32 v41, v41, v51
  v_add_f32 v42, v42, v52
  v_add_f32 v43, v43, v53
  v_add_f32 v44, v44, v54
  v_add_f32 v45, v45, v55
  v_add_f32 v46, v46, v56
  v_add_f32 v47, v47, v57
  v_add_f32 v48, v48, v58
  v_cvt_pk_bf16_f32 v64, v40, v41
  v_cvt_pk_bf16_f32 v65, v42, v43
  v_cvt_pk_bf16_f32 v66, v44, v45
  v_cvt_pk_bf16_f32 v67, v46, v47
  v_cvt_pk_bf16_f32 v48, v48, v48
  v_and_b32 v48, 0xffff0000, v48
  v_lshlrev_b32 v40, 16, v64
  v_and_b32 v41, 0xffff0000, v64
  v_lshlrev_b32 v42, 16, v65
  v_and_b32 v43, 0xffff0000, v65
  v_lshlrev_b32 v44, 16, v66
  v_and_b32 v45, 0xffff0000, v66
  v_lshlrev_b32 v46, 16, v67
  v_and_b32 v47, 0xffff0000, v67
  v_mul_f32 v40, v34, v40
  v_mul_f32 v41, v34, v41
  v_mul_f32 v42, v34, v42
  v_mul_f32 v43, v34, v43
  v_mul_f32 v44, v34, v44
  v_mul_f32 v45, v34, v45
  v_mul_f32 v46, v34, v46
  v_mul_f32 v47, v34, v47
  v_mul_f32 v48, v34, v48
  v_cvt_pk_bf16_f32 v64, v40, v41
  v_cvt_pk_bf16_f32 v65, v42, v43
  v_cvt_pk_bf16_f32 v66, v44, v45
  v_cvt_pk_bf16_f32 v67, v46, v47
  v_cvt_pk_bf16_f32 v48, v48, v48
  v_and_b32 v48, 0xffff0000, v48
  v_lshlrev_b32 v40, 16, v64
  v_and_b32 v41, 0xffff0000, v64
  v_lshlrev_b32 v42, 16, v65
  v_and_b32 v43, 0xffff0000, v65
  v_lshlrev_b32 v44, 16, v66
  v_and_b32 v45, 0xffff0000, v66
  v_lshlrev_b32 v46, 16, v67
  v_and_b32 v47, 0xffff0000, v67
  v_add_f32 v40, v40, v25
  v_add_f32 v41, v41, v26
  v_add_f32 v42, v42, v27
  v_add_f32 v43, v43, v28
  v_add_f32 v44, v44, v29
  v_add_f32 v45, v45, v30
  v_add_f32 v46, v46, v31
  v_add_f32 v47, v47, v32
  v_add_f32 v48, v48, v33
  v_cvt_pk_bf16_f32 v64, v40, v41
  v_cvt_pk_bf16_f32 v65, v42, v43
  v_cvt_pk_bf16_f32 v66, v44, v45
  v_cvt_pk_bf16_f32 v67, v46, v47
  v_cvt_pk_bf16_f32 v48, v48, v48
  buffer_store_dwordx4 v[64:67], v9, s[44:47], 0 offen
  buffer_store_short v48, v10, s[44:47], 0 offen offset:128
L_fin:
  s_branch L_end
L_yfast:
  s_mov_b32 exec_hi, 0xf
  s_mul_i32 s57, s80, 576
  s_add_u32 s57, s57, 229376
  buffer_load_dwordx4 v[112:115], v3, s[40:43], s57 offen sc1
  s_add_u32 s57, s57, 4608
  buffer_load_dwordx4 v[116:119], v3, s[40:43], s57 offen sc1
  s_add_u32 s57, s57, 4608
  buffer_load_dwordx4 v[120:123], v3, s[40:43], s57 offen sc1
  s_add_u32 s57, s57, 4608
  buffer_load_dwordx4 v[124:127], v3, s[40:43], s57 offen sc1
  s_add_u32 s57, s57, 4608
  buffer_load_dwordx4 v[128:131], v3, s[40:43], s57 offen sc1
  s_add_u32 s57, s57, 4608
  buffer_load_dwordx4 v[132:135], v3, s[40:43], s57 offen sc1
  s_add_u32 s57, s57, 4608
  buffer_load_dwordx4 v[136:139], v3, s[40:43], s57 offen sc1
  s_add_u32 s57, s57, 4608
  buffer_load_dwordx4 v[140:143], v3, s[40:43], s57 offen sc1
  s_add_u32 s57, s57, 4608
  buffer_load_dwordx4 v[144:147], v3, s[40:43], s57 offen sc1
  s_add_u32 s57, s57, 4608
  buffer_load_dwordx4 v[148:151], v3, s[40:43], s57 offen sc1
  s_add_u32 s57, s57, 4608
  buffer_load_dwordx4 v[152:155], v3, s[40:43], s57 offen sc1
  s_add_u32 s57, s57, 4608
  buffer_load_dwordx4 v[156:159], v3, s[40:43], s57 offen sc1
  s_add_u32 s57, s57, 4608
  buffer_load_dwordx4 v[160:163], v3, s[40:43], s57 offen sc1
  s_add_u32 s57, s57, 4608
  buffer_load_dwordx4 v[164:167], v3, s[40:43], s57 offen sc1
  s_add_u32 s57, s57, 4608
  buffer_load_dwordx4 v[168:171], v3, s[40:43], s57 offen sc1
  s_add_u32 s57, s57, 4608
  buffer_load_dwordx4 v[172:175], v3, s[40:43], s57 offen sc1
  s_add_u32 s57, s57, 4608
  buffer_load_dwordx4 v[176:179], v3, s[40:43], s57 offen sc1
  s_add_u32 s57, s57, 4608
  buffer_load_dwordx4 v[180:183], v3, s[40:43], s57 offen sc1
  s_add_u32 s57, s57, 4608
  buffer_load_dwordx4 v[184:187], v3, s[40:43], s57 offen sc1
  s_add_u32 s57, s57, 4608
  buffer_load_dwordx4 v[188:191], v3, s[40:43], s57 offen sc1
  s_add_u32 s57, s57, 4608
  buffer_load_dwordx4 v[192:195], v3, s[40:43], s57 offen sc1
  s_mov_b32 exec_hi, -1
  s_waitcnt vmcnt(26) lgkmcnt(0)
  v_mfma_f32_16x16x32_bf16 v[72:75], v[212:215], v[60:63], v[72:75]
  v_mfma_f32_16x16x32_bf16 v[76:79], v[216:219], v[60:63], v[76:79]
  v_mfma_f32_16x16x32_bf16 v[80:83], v[220:223], v[60:63], v[80:83]
  v_mfma_f32_16x16x32_bf16 v[84:87], v[224:227], v[60:63], v[84:87]
  v_mfma_f32_16x16x32_bf16 v[88:91], v[228:231], v[60:63], v[88:91]
  s_waitcnt vmcnt(25) lgkmcnt(0)
  v_mfma_f32_16x16x32_bf16 v[72:75], v[232:235], v[64:67], v[72:75]
  v_mfma_f32_16x16x32_bf16 v[76:79], v[236:239], v[64:67], v[76:79]
  v_mfma_f32_16x16x32_bf16 v[80:83], v[240:243], v[64:67], v[80:83]
  v_mfma_f32_16x16x32_bf16 v[84:87], v[244:247], v[64:67], v[84:87]
  v_mfma_f32_16x16x32_bf16 v[88:91], v[248:251], v[64:67], v[88:91]
  s_waitcnt vmcnt(21) lgkmcnt(0)
  v_mfma_f32_16x16x32_bf16 v[72:75], v[92:95], v[68:71], v[72:75]
  v_mfma_f32_16x16x32_bf16 v[76:79], v[96:99], v[68:71], v[76:79]
  v_mfma_f32_16x16x32_bf16 v[80:83], v[100:103], v[68:71], v[80:83]
  v_mfma_f32_16x16x32_bf16 v[84:87], v[104:107], v[68:71], v[84:87]
  v_mfma_f32_16x16x32_bf16 v[88:91], v[108:111], v[68:71], v[88:91]
  s_mov_b32 exec_hi, 0xf
  s_mov_b32 s58, 0
  s_branch L_ygot
L_exact:
  s_waitcnt vmcnt(0)
  s_mov_b32 s74, 1
  v_mov_b32 v25, 0
  ds_read_b128 v[28:31], v4 offset:4096
  ds_read_b32 v32, v5 offset:2048
  v_mov_b32 v52, 4048155338
  v_mov_b32 v53, 4048155338
  s_waitcnt lgkmcnt(0)
  v_mfma_f32_32x32x16_bf16 v[64:79], v[28:31], v[20:23], v[112:127]
  v_mfma_f32_32x32x16_bf16 v[64:79], v[32:35], v[24:27], v[64:79]
  ds_read_b128 v[28:31], v4 offset:3584
  ds_read_b32 v32, v5 offset:1792
  s_nop 7
  s_waitcnt lgkmcnt(0)
  v_mfma_f32_32x32x16_bf16 v[80:95], v[28:31], v[20:23], 0
  v_mfma_f32_32x32x16_bf16 v[80:95], v[32:35], v[24:27], v[80:95]
  ds_read_b128 v[28:31], v4 offset:3072
  ds_read_b32 v32, v5 offset:1536
  v_max3_f32 v52, v52, v64, v65
  v_max3_f32 v53, v53, v66, v67
  v_max3_f32 v52, v52, v68, v69
  v_max3_f32 v53, v53, v70, v71
  v_max3_f32 v52, v52, v72, v73
  v_max3_f32 v53, v53, v74, v75
  v_max3_f32 v52, v52, v76, v77
  v_max3_f32 v53, v53, v78, v79
  s_cmp_eq_u32 s82, 8
  s_cbranch_scc1 L_exdone
  s_waitcnt lgkmcnt(0)
  v_mfma_f32_32x32x16_bf16 v[64:79], v[28:31], v[20:23], 0
  v_mfma_f32_32x32x16_bf16 v[64:79], v[32:35], v[24:27], v[64:79]
  ds_read_b128 v[28:31], v4 offset:2560
  ds_read_b32 v32, v5 offset:1280
  v_max3_f32 v52, v52, v80, v81
  v_max3_f32 v53, v53, v82, v83
  v_max3_f32 v52, v52, v84, v85
  v_max3_f32 v53, v53, v86, v87
  v_max3_f32 v52, v52, v88, v89
  v_max3_f32 v53, v53, v90, v91
  v_max3_f32 v52, v52, v92, v93
  v_max3_f32 v53, v53, v94, v95
  s_cmp_eq_u32 s82, 7
  s_cbranch_scc1 L_exdone
  s_waitcnt lgkmcnt(0)
  v_mfma_f32_32x32x16_bf16 v[80:95], v[28:31], v[20:23], 0
  v_mfma_f32_32x32x16_bf16 v[80:95], v[32:35], v[24:27], v[80:95]
  ds_read_b128 v[28:31], v4 offset:2048
  ds_read_b32 v32, v5 offset:1024
  v_max3_f32 v52, v52, v64, v65
  v_max3_f32 v53, v53, v66, v67
  v_max3_f32 v52, v52, v68, v69
  v_max3_f32 v53, v53, v70, v71
  v_max3_f32 v52, v52, v72, v73
  v_max3_f32 v53, v53, v74, v75
  v_max3_f32 v52, v52, v76, v77
  v_max3_f32 v53, v53, v78, v79
  s_cmp_eq_u32 s82, 6
  s_cbranch_scc1 L_exdone
  s_waitcnt lgkmcnt(0)
  v_mfma_f32_32x32x16_bf16 v[64:79], v[28:31], v[20:23], 0
  v_mfma_f32_32x32x16_bf16 v[64:79], v[32:35], v[24:27], v[64:79]
  ds_read_b128 v[28:31], v4 offset:1536
  ds_read_b32 v32, v5 offset:768
  v_max3_f32 v52, v52, v80, v81
  v_max3_f32 v53, v53, v82, v83
  v_max3_f32 v52, v52, v84, v85
  v_max3_f32 v53, v53, v86, v87
  v_max3_f32 v52, v52, v88, v89
  v_max3_f32 v53, v53, v90, v91
  v_max3_f32 v52, v52, v92, v93
  v_max3_f32 v53, v53, v94, v95
  s_cmp_eq_u32 s82, 5
  s_cbranch_scc1 L_exdone
  s_waitcnt lgkmcnt(0)
  v_mfma_f32_32x32x16_bf16 v[80:95], v[28:31], v[20:23], 0
  v_mfma_f32_32x32x16_bf16 v[80:95], v[32:35], v[24:27], v[80:95]
  ds_read_b128 v[28:31], v4 offset:1024
  ds_read_b32 v32, v5 offset:512
  v_max3_f32 v52, v52, v64, v65
  v_max3_f32 v53, v53, v66, v67
  v_max3_f32 v52, v52, v68, v69
  v_max3_f32 v53, v53, v70, v71
  v_max3_f32 v52, v52, v72, v73
  v_max3_f32 v53, v53, v74, v75
  v_max3_f32 v52, v52, v76, v77
  v_max3_f32 v53, v53, v78, v79
  s_cmp_eq_u32 s82, 4
  s_cbranch_scc1 L_exdone
  s_waitcnt lgkmcnt(0)
  v_mfma_f32_32x32x16_bf16 v[64:79], v[28:31], v[20:23], 0
  v_mfma_f32_32x32x16_bf16 v[64:79], v[32:35], v[24:27], v[64:79]
  ds_read_b128 v[28:31], v4 offset:512
  ds_read_b32 v32, v5 offset:256
  v_max3_f32 v52, v52, v80, v81
  v_max3_f32 v53, v53, v82, v83
  v_max3_f32 v52, v52, v84, v85
  v_max3_f32 v53, v53, v86, v87
  v_max3_f32 v52, v52, v88, v89
  v_max3_f32 v53, v53, v90, v91
  v_max3_f32 v52, v52, v92, v93
  v_max3_f32 v53, v53, v94, v95
  s_cmp_eq_u32 s82, 3
  s_cbranch_scc1 L_exdone
  s_waitcnt lgkmcnt(0)
  v_mfma_f32_32x32x16_bf16 v[80:95], v[28:31], v[20:23], 0
  v_mfma_f32_32x32x16_bf16 v[80:95], v[32:35], v[24:27], v[80:95]
  ds_read_b128 v[28:31], v4 offset:0
  ds_read_b32 v32, v5 offset:0
  v_max3_f32 v52, v52, v64, v65
  v_max3_f32 v53, v53, v66, v67
  v_max3_f32 v52, v52, v68, v69
  v_max3_f32 v53, v53, v70, v71
  v_max3_f32 v52, v52, v72, v73
  v_max3_f32 v53, v53, v74, v75
  v_max3_f32 v52, v52, v76, v77
  v_max3_f32 v53, v53, v78, v79
  s_cmp_eq_u32 s82, 2
  s_cbranch_scc1 L_exdone
  s_waitcnt lgkmcnt(0)
  v_mfma_f32_32x32x16_bf16 v[64:79], v[28:31], v[20:23], v[128:143]
  v_mfma_f32_32x32x16_bf16 v[64:79], v[32:35], v[24:27], v[64:79]
  s_nop 1
  v_max3_f32 v52, v52, v80, v81
  v_max3_f32 v53, v53, v82, v83
  v_max3_f32 v52, v52, v84, v85
  v_max3_f32 v53, v53, v86, v87
  v_max3_f32 v52, v52, v88, v89
  v_max3_f32 v53, v53, v90, v91
  v_max3_f32 v52, v52, v92, v93
  v_max3_f32 v53, v53, v94, v95
  s_cmp_eq_u32 s82, 1
  s_cbranch_scc1 L_exdone
  s_nop 4
  v_max3_f32 v52, v52, v64, v65
  v_max3_f32 v53, v53, v66, v67
  v_max3_f32 v52, v52, v68, v69
  v_max3_f32 v53, v53, v70, v71
  v_max3_f32 v52, v52, v72, v73
  v_max3_f32 v53, v53, v74, v75
  v_max3_f32 v52, v52, v76, v77
  v_max3_f32 v53, v53, v78, v79
L_exdone:
  s_waitcnt lgkmcnt(0)
  ds_read_b128 v[28:31], v4 offset:4096
  ds_read_b32 v32, v5 offset:2048
  s_nop 7
  s_waitcnt lgkmcnt(0)
  v_mfma_f32_32x32x16_bf16 v[64:79], v[28:31], v[20:23], v[112:127]
  v_mfma_f32_32x32x16_bf16 v[64:79], v[32:35], v[24:27], v[64:79]
  ds_read_b128 v[28:31], v4 offset:3584
  ds_read_b32 v32, v5 offset:1792
  v_mov_b32 v96, 0
  v_mov_b32 v97, 0
  v_mov_b32 v98, 0
  v_mov_b32 v99, 0
  v_mov_b32 v100, 0
  v_mov_b32 v101, 0
  v_mov_b32 v102, 0
  v_mov_b32 v103, 0
  v_mov_b32 v104, 0
  v_mov_b32 v105, 0
  v_mov_b32 v106, 0
  v_mov_b32 v107, 0
  v_mov_b32 v108, 0
  v_mov_b32 v109, 0
  v_mov_b32 v110, 0
  v_mov_b32 v111, 0
  s_branch L_p1done
L_end:
  s_endpgm
.section .rodata,"a"
.p2align 6
.amdhsa_kernel gated_mix__sliding_block__moe_arch_mod__prompt_kernel
  .amdhsa_next_free_vgpr 256
  .amdhsa_next_free_sgpr 102
  .amdhsa_accum_offset 256
  .amdhsa_group_segment_fixed_size 0
  .amdhsa_kernarg_size 96
  .amdhsa_user_sgpr_count 2
  .amdhsa_user_sgpr_kernarg_segment_ptr 1
  .amdhsa_system_sgpr_workgroup_id_x 1
.end_amdhsa_kernel
```
